```python
import torch

def _softmax(x, axis=-1):
    return torch.softmax(x, dim=axis)
def _gelu(x):
    return torch.nn.functional.gelu(x, approximate="tanh")
def _silu(x):
    return torch.nn.functional.silu(x)
def _sigmoid(x):
    return torch.sigmoid(x)
def _layernorm(x, axis=-1, eps=1e-5):
    m = x.mean(dim=axis, keepdim=True)
    v = x.var(dim=axis, keepdim=True, unbiased=False)
    return (x - m) / torch.sqrt(v + eps)
def _scatter_add(tgt, idx, src, axis=0):
    return tgt.clone().index_add_(axis, idx, src)
def _segment_sum(src, seg, n):
    out = torch.zeros((n,) + src.shape[1:], dtype=src.dtype)
    return out.index_add_(0, seg, src)
def _pad(x, pw):
    flat = tuple(v for pair in reversed(pw) for v in pair)
    return torch.nn.functional.pad(x, flat)

kernel_name = 'standalone__detection_seg_fpn_lateral__vision'

def setup_inputs():

    _w = (lambda a: (lambda t: t.to(torch.bfloat16) if t.is_floating_point() else t)(torch.as_tensor(a)))
    H = W = (512 // 2) * 2
    C = 96
    k = 1
    return {
        "c_fine": _w((lambda *s: torch.randn(*s, dtype=torch.bfloat16) * 0.05)(1, H, W, C)),
        "p_coarse": _w((lambda *s: torch.randn(*s, dtype=torch.bfloat16) * 0.05)(1, H // 2, W // 2, C)),
        "w_lat": _w((lambda *s: torch.randn(*s, dtype=torch.bfloat16) * 0.05)(C, C)),
        "w_out": _w((lambda *s: torch.randn(*s, dtype=torch.bfloat16) * 0.05)(k, k, C, C)),
    }

def reference(c_fine, p_coarse, w_lat, w_out):
    B, H, W, C = c_fine.shape
    k = 1
    lat = torch.einsum("bhwc,cd->bhwd", c_fine, w_lat)
    up = (lambda x, n, axis: torch.repeat_interleave(x, n, dim=axis))((lambda x, n, axis: torch.repeat_interleave(x, n, dim=axis))(p_coarse, 2, axis=1), 2, axis=2)
    m = lat + up
    pad = k // 2
    mp = _pad(m, ((0, 0), (pad, pad), (pad, pad), (0, 0)))
    o = None
    for di in range(k):
        for dj in range(k):
            t = torch.einsum("bhwc,cd->bhwd", mp[:, di:di + H, dj:dj + W, :], w_out[di, dj])
            o = t if o is None else o + t
    return o
```

```asm
; @launch grid=(256,1,1) block=(384,1,1) lds=159808
.amdgcn_target "amdgcn-amd-amdhsa--gfx950"
.text
.globl standalone__detection_seg_fpn_lateral__vision_kernel
.p2align 8
.type standalone__detection_seg_fpn_lateral__vision_kernel,@function
standalone__detection_seg_fpn_lateral__vision_kernel:
    s_memtime s[4:5]
    s_load_dwordx4 s[8:11], s[0:1], 0
    s_load_dwordx4 s[20:23], s[0:1], 16
    s_load_dwordx4 s[16:19], s[0:1], 32
    v_lshrrev_b32 v6, 6, v0
    s_cmp_ge_u32 s2, 256
    s_cbranch_scc1 L_end
    v_readfirstlane_b32 s3, v6
    v_and_b32 v0, 63, v0
    v_mov_b32 v5, 159744
    s_cmp_gt_u32 s3, 1
    s_cbranch_scc1 L_compute
    s_cmp_eq_u32 s3, 1
    s_cbranch_scc1 L_common
    s_getpc_b64 s[32:33]
L_pc:
    s_bfe_u32 s34, s2, 0x40003
    s_mul_i32 s34, s34, 10
    v_min_u32 v7, 9, v0
    v_add_lshl_u32 v7, v7, s34, 7
    v_min_u32 v7, L_end-L_pc, v7
    global_load_dword v10, v7, s[32:33]
L_common:
    s_lshr_b32 s35, s2, 3
    s_and_b32 s33, s2, 3
    s_lshl2_add_u32 s42, s35, s33
    s_bfe_u32 s6, s2, 0x10002
    s_mul_i32 s29, s42, 98304
    s_and_b32 s32, s42, 15
    s_cmp_eq_u32 s32, 10
    s_cselect_b32 s39, 49152, 0
    s_add_u32 s29, s29, s39
    s_lshl_b32 s28, s29, 2
    s_lshr_b32 s32, 0x96969696, s35
    s_and_b32 s32, s32, 1
    s_lshl2_add_u32 s30, s6, s32
    s_lshr_b32 s32, 0x55aa55aa, s35
    s_and_b32 s32, s32, 1
    s_lshl1_add_u32 s30, s32, s30
    s_cmp_eq_u32 s3, 0
    s_cbranch_scc1 L_probe
    v_lshlrev_b32 v4, 4, v0
    v_mul_u32_u24 v6, 2731, v0
    v_bfe_u32 v6, v6, 16, 3
    v_xor_b32 v6, v6, v0
    v_lshlrev_b32 v174, 4, v6
    v_add_u32 v6, 64, v0
    v_mul_u32_u24 v6, 2731, v6
    v_bfe_u32 v6, v6, 16, 3
    v_xor_b32 v6, v6, v0
    v_lshlrev_b32 v175, 4, v6
    v_add_u32 v6, 128, v0
    v_mul_u32_u24 v6, 2731, v6
    v_bfe_u32 v6, v6, 16, 3
    v_xor_b32 v6, v6, v0
    v_lshlrev_b32 v176, 4, v6
    v_add_u32 v1, 2048, v174
    v_add_u32 v2, 2048, v175
    v_lshrrev_b32 v170, 4, v0
    v_min_u32 v170, 1, v170
    v_sub_u32 v6, 1, v170
    v_lshl_add_u32 v3, v6, 11, v176
    v_lshlrev_b32 v170, 1, v170
    s_mov_b32 s60, 0x24924924
    s_mov_b32 s61, 0x49249249
    s_xor_b32 s32, s30, 0
    s_lshl_b32 s33, s32, 1
    s_sub_u32 s33, 34, s33
    s_lshr_b64 s[62:63], s[60:61], s33
    s_lshl_b32 s32, s32, 10
    s_add_u32 s37, s29, s32
    s_lshl_b32 s32, s32, 1
    s_add_u32 s44, s28, s32
    v_bfe_u32 v16, s62, 0, 2
    v_bfe_u32 v17, s62, 0, 2
    v_bfe_u32 v18, s62, v170, 2
    v_lshl_add_u32 v16, v16, 15, v1
    v_lshl_add_u32 v17, v17, 15, v2
    v_lshl_add_u32 v18, v18, 15, v3
    s_branch L_mem
L_probe:
    v_mov_b32 v8, 0
    s_lshl_b32 s43, s30, 11
    s_waitcnt lgkmcnt(6)
    s_and_b32 s33, s4, 0x19380
    s_xor_b32 s43, s43, s33
    s_add_u32 s43, s43, s28
    s_add_u32 s43, s43, 512
    s_xor_b32 s34, s43, 0x800
    s_xor_b32 s43, s43, 0x2000
    s_waitcnt lgkmcnt(0)
    s_mov_b32 s10, 50331648
    s_mov_b32 s11, 0x20000
    buffer_load_dword v12, v8, s[8:11], s43 offen nt
    buffer_load_dword v13, v8, s[8:11], s34 offen nt
    s_waitcnt vmcnt(1)
    s_memtime s[40:41]
    s_waitcnt vmcnt(0)
    s_memtime s[38:39]
    s_branch L_help
L_mem:
    s_mov_b32 s26, 18432
    s_mov_b32 s27, 0x20000
    s_setprio 3
    s_waitcnt lgkmcnt(0)
    s_sub_u32 s12, s10, 2176
    s_subb_u32 s13, s11, 0
    s_sub_u32 s8, s8, 2304
    s_subb_u32 s9, s9, 0
    s_mov_b32 s10, 50333952
    s_mov_b32 s11, 0x20000
    s_mov_b32 m0, 3072
    s_add_u32 s32, s44, 0
    buffer_load_dwordx4 v16, s[8:11], s32 offen offset:0 nt lds
    buffer_load_dwordx4 v17, s[8:11], s32 offen offset:1024 nt lds
    buffer_load_dwordx4 v18, s[8:11], s32 offen offset:2048 nt lds
    s_mov_b64 s[24:25], s[22:23]
    s_mov_b32 s22, 18432
    s_mov_b32 s23, 0x20000
    s_mov_b32 m0, 141312
    s_movk_i32 s32, 0
    buffer_load_dwordx4 v4, s[20:23], s32 offen offset:0 lds
    buffer_load_dwordx4 v4, s[20:23], s32 offen offset:1024 lds
    buffer_load_dwordx4 v4, s[20:23], s32 offen offset:2048 lds
    s_mov_b32 m0, 9216
    s_add_u32 s32, s44, 98304
    buffer_load_dwordx4 v16, s[8:11], s32 offen offset:0 nt lds
    buffer_load_dwordx4 v17, s[8:11], s32 offen offset:1024 nt lds
    buffer_load_dwordx4 v18, s[8:11], s32 offen offset:2048 nt lds
    s_mov_b32 m0, 144384
    s_movk_i32 s32, 3072
    buffer_load_dwordx4 v4, s[20:23], s32 offen offset:0 lds
    buffer_load_dwordx4 v4, s[20:23], s32 offen offset:1024 lds
    buffer_load_dwordx4 v4, s[20:23], s32 offen offset:2048 lds
    s_mov_b32 s14, 12585088
    s_mov_b32 s15, 0x20000
    v_lshrrev_b32 v171, 5, v0
    v_lshlrev_b32 v171, 1, v171
    v_sub_u32 v6, 3, v171
    v_add_u32 v174, 3072, v174
    v_lshl_add_u32 v175, v6, 10, v175
    v_add_u32 v176, 1024, v176
    v_add_u32 v171, 2, v171
    v_add_u32 v164, 2048, v4
    v_lshrrev_b32 v167, 3, v0
    v_min_u32 v167, 1, v167
    v_sub_u32 v6, 2, v167
    v_lshl_add_u32 v165, v6, 10, v4
    v_lshlrev_b32 v167, 1, v167
    v_sub_u32 v6, 2, v170
    v_lshl_add_u32 v166, v6, 9, v4
    v_add_u32 v168, 2, v170
    v_bfe_u32 v19, s62, 2, 2
    v_bfe_u32 v20, s62, v171, 2
    v_bfe_u32 v21, s62, 4, 2
    v_lshl_add_u32 v19, v19, 15, v174
    v_lshl_add_u32 v20, v20, 15, v175
    v_lshl_add_u32 v21, v21, 15, v176
    v_bfe_u32 v12, s62, 0, 2
    v_bfe_u32 v13, s62, v167, 2
    v_bfe_u32 v14, s62, v168, 2
    s_mov_b32 m0, 0
    v_lshl_add_u32 v12, v12, 14, v164
    v_lshl_add_u32 v13, v13, 14, v165
    v_lshl_add_u32 v14, v14, 14, v166
    buffer_load_dwordx4 v12, s[12:15], s37 offen offset:0 nt lds
    buffer_load_dwordx4 v13, s[12:15], s37 offen offset:1024 nt lds
    buffer_load_dwordx4 v14, s[12:15], s37 offen offset:2048 nt lds
    s_mov_b32 m0, 147456
    s_movk_i32 s32, 6144
    buffer_load_dwordx4 v4, s[20:23], s32 offen offset:0 lds
    buffer_load_dwordx4 v4, s[20:23], s32 offen offset:1024 lds
    buffer_load_dwordx4 v4, s[20:23], s32 offen offset:2048 lds
    s_mov_b32 m0, 150528
    s_movk_i32 s32, 9216
    buffer_load_dwordx4 v4, s[20:23], s32 offen offset:0 lds
    buffer_load_dwordx4 v4, s[20:23], s32 offen offset:1024 lds
    buffer_load_dwordx4 v4, s[20:23], s32 offen offset:2048 lds
    s_mov_b32 m0, 6144
    s_add_u32 s32, s44, 0
    buffer_load_dwordx4 v19, s[8:11], s32 offen offset:0 nt lds
    buffer_load_dwordx4 v20, s[8:11], s32 offen offset:1024 nt lds
    buffer_load_dwordx4 v21, s[8:11], s32 offen offset:2048 nt lds
    s_mov_b32 m0, 153600
    s_movk_i32 s32, 12288
    buffer_load_dwordx4 v4, s[20:23], s32 offen offset:0 lds
    buffer_load_dwordx4 v4, s[20:23], s32 offen offset:1024 lds
    buffer_load_dwordx4 v4, s[20:23], s32 offen offset:2048 lds
    s_mov_b32 m0, 12288
    s_add_u32 s32, s44, 98304
    buffer_load_dwordx4 v19, s[8:11], s32 offen offset:0 nt lds
    buffer_load_dwordx4 v20, s[8:11], s32 offen offset:1024 nt lds
    buffer_load_dwordx4 v21, s[8:11], s32 offen offset:2048 nt lds
    s_mov_b32 m0, 156672
    s_movk_i32 s32, 15360
    buffer_load_dwordx4 v4, s[20:23], s32 offen offset:0 lds
    buffer_load_dwordx4 v4, s[20:23], s32 offen offset:1024 lds
    buffer_load_dwordx4 v4, s[20:23], s32 offen offset:2048 lds
    s_mov_b32 m0, 122880
    s_movk_i32 s32, 0
    buffer_load_dwordx4 v4, s[24:27], s32 offen offset:0 lds
    buffer_load_dwordx4 v4, s[24:27], s32 offen offset:1024 lds
    buffer_load_dwordx4 v4, s[24:27], s32 offen offset:2048 lds
    s_xor_b32 s32, s30, 5
    s_lshl_b32 s33, s32, 1
    s_sub_u32 s33, 34, s33
    s_lshr_b64 s[62:63], s[60:61], s33
    s_lshl_b32 s32, s32, 10
    s_add_u32 s37, s29, s32
    s_lshl_b32 s32, s32, 1
    s_add_u32 s45, s28, s32
    v_bfe_u32 v22, s62, 0, 2
    v_bfe_u32 v23, s62, 0, 2
    v_bfe_u32 v24, s62, v170, 2
    v_lshl_add_u32 v22, v22, 15, v1
    v_lshl_add_u32 v23, v23, 15, v2
    v_lshl_add_u32 v24, v24, 15, v3
    v_bfe_u32 v25, s62, 2, 2
    v_bfe_u32 v26, s62, v171, 2
    v_bfe_u32 v27, s62, 4, 2
    v_lshl_add_u32 v25, v25, 15, v174
    v_lshl_add_u32 v26, v26, 15, v175
    v_lshl_add_u32 v27, v27, 15, v176
    v_bfe_u32 v12, s62, 0, 2
    v_bfe_u32 v13, s62, v167, 2
    v_bfe_u32 v14, s62, v168, 2
    s_mov_b32 m0, 15360
    v_lshl_add_u32 v12, v12, 14, v164
    v_lshl_add_u32 v13, v13, 14, v165
    v_lshl_add_u32 v14, v14, 14, v166
    buffer_load_dwordx4 v12, s[12:15], s37 offen offset:0 nt lds
    buffer_load_dwordx4 v13, s[12:15], s37 offen offset:1024 nt lds
    buffer_load_dwordx4 v14, s[12:15], s37 offen offset:2048 nt lds
    s_mov_b32 m0, 125952
    s_movk_i32 s32, 3072
    buffer_load_dwordx4 v4, s[24:27], s32 offen offset:0 lds
    buffer_load_dwordx4 v4, s[24:27], s32 offen offset:1024 lds
    buffer_load_dwordx4 v4, s[24:27], s32 offen offset:2048 lds
    s_mov_b32 m0, 18432
    s_add_u32 s32, s45, 0
    buffer_load_dwordx4 v22, s[8:11], s32 offen offset:0 nt lds
    buffer_load_dwordx4 v23, s[8:11], s32 offen offset:1024 nt lds
    buffer_load_dwordx4 v24, s[8:11], s32 offen offset:2048 nt lds
    s_mov_b32 m0, 129024
    s_movk_i32 s32, 6144
    buffer_load_dwordx4 v4, s[24:27], s32 offen offset:0 lds
    buffer_load_dwordx4 v4, s[24:27], s32 offen offset:1024 lds
    buffer_load_dwordx4 v4, s[24:27], s32 offen offset:2048 lds
    s_sub_u32 s16, s16, 2304
    s_subb_u32 s17, s17, 0
    s_mov_b32 s18, 50333952
    s_mov_b32 s19, 0x20000
    v_add_u32 v9, 61440, v4
    v_add_u32 v11, 122880, v4
    s_barrier
    s_mov_b32 m0, 132096
    s_movk_i32 s32, 9216
    buffer_load_dwordx4 v4, s[24:27], s32 offen offset:0 lds
    buffer_load_dwordx4 v4, s[24:27], s32 offen offset:1024 lds
    buffer_load_dwordx4 v4, s[24:27], s32 offen offset:2048 lds
    s_mov_b32 m0, 24576
    s_add_u32 s32, s45, 98304
    buffer_load_dwordx4 v22, s[8:11], s32 offen offset:0 nt lds
    buffer_load_dwordx4 v23, s[8:11], s32 offen offset:1024 nt lds
    buffer_load_dwordx4 v24, s[8:11], s32 offen offset:2048 nt lds
    s_mov_b32 m0, 135168
    s_movk_i32 s32, 12288
    buffer_load_dwordx4 v4, s[24:27], s32 offen offset:0 lds
    buffer_load_dwordx4 v4, s[24:27], s32 offen offset:1024 lds
    buffer_load_dwordx4 v4, s[24:27], s32 offen offset:2048 lds
    s_mov_b32 m0, 21504
    s_add_u32 s32, s45, 0
    buffer_load_dwordx4 v25, s[8:11], s32 offen offset:0 nt lds
    buffer_load_dwordx4 v26, s[8:11], s32 offen offset:1024 nt lds
    buffer_load_dwordx4 v27, s[8:11], s32 offen offset:2048 nt lds
    s_mov_b32 m0, 138240
    s_movk_i32 s32, 15360
    buffer_load_dwordx4 v4, s[24:27], s32 offen offset:0 lds
    buffer_load_dwordx4 v4, s[24:27], s32 offen offset:1024 lds
    buffer_load_dwordx4 v4, s[24:27], s32 offen offset:2048 lds
    s_mov_b32 m0, 27648
    s_add_u32 s32, s45, 98304
    buffer_load_dwordx4 v25, s[8:11], s32 offen offset:0 nt lds
    buffer_load_dwordx4 v26, s[8:11], s32 offen offset:1024 nt lds
    buffer_load_dwordx4 v27, s[8:11], s32 offen offset:2048 nt lds
    s_xor_b32 s32, s30, 2
    s_lshl_b32 s33, s32, 1
    s_sub_u32 s33, 34, s33
    s_lshr_b64 s[62:63], s[60:61], s33
    s_lshl_b32 s32, s32, 10
    s_add_u32 s37, s29, s32
    s_lshl_b32 s32, s32, 1
    s_add_u32 s46, s28, s32
    v_bfe_u32 v28, s62, 0, 2
    v_bfe_u32 v29, s62, 0, 2
    v_bfe_u32 v30, s62, v170, 2
    v_lshl_add_u32 v28, v28, 15, v1
    v_lshl_add_u32 v29, v29, 15, v2
    v_lshl_add_u32 v30, v30, 15, v3
    v_bfe_u32 v31, s62, 2, 2
    v_bfe_u32 v32, s62, v171, 2
    v_bfe_u32 v33, s62, 4, 2
    v_lshl_add_u32 v31, v31, 15, v174
    v_lshl_add_u32 v32, v32, 15, v175
    v_lshl_add_u32 v33, v33, 15, v176
    v_bfe_u32 v12, s62, 0, 2
    v_bfe_u32 v13, s62, v167, 2
    v_bfe_u32 v14, s62, v168, 2
    s_mov_b32 m0, 30720
    v_lshl_add_u32 v12, v12, 14, v164
    v_lshl_add_u32 v13, v13, 14, v165
    v_lshl_add_u32 v14, v14, 14, v166
    buffer_load_dwordx4 v12, s[12:15], s37 offen offset:0 nt lds
    buffer_load_dwordx4 v13, s[12:15], s37 offen offset:1024 nt lds
    buffer_load_dwordx4 v14, s[12:15], s37 offen offset:2048 nt lds
    s_mov_b32 m0, 33792
    s_add_u32 s32, s46, 0
    buffer_load_dwordx4 v28, s[8:11], s32 offen offset:0 nt lds
    buffer_load_dwordx4 v29, s[8:11], s32 offen offset:1024 nt lds
    buffer_load_dwordx4 v30, s[8:11], s32 offen offset:2048 nt lds
    s_mov_b32 m0, 39936
    s_add_u32 s32, s46, 98304
    buffer_load_dwordx4 v28, s[8:11], s32 offen offset:0 nt lds
    buffer_load_dwordx4 v29, s[8:11], s32 offen offset:1024 nt lds
    buffer_load_dwordx4 v30, s[8:11], s32 offen offset:2048 nt lds
    s_mov_b32 m0, 36864
    s_add_u32 s32, s46, 0
    buffer_load_dwordx4 v31, s[8:11], s32 offen offset:0 nt lds
    buffer_load_dwordx4 v32, s[8:11], s32 offen offset:1024 nt lds
    buffer_load_dwordx4 v33, s[8:11], s32 offen offset:2048 nt lds
    s_waitcnt vmcnt(36)
    v_mov_b32 v6, 1
    ds_write_b32 v5, v6 offset:0
    s_mov_b32 m0, 43008
    s_add_u32 s32, s46, 98304
    buffer_load_dwordx4 v31, s[8:11], s32 offen offset:0 nt lds
    buffer_load_dwordx4 v32, s[8:11], s32 offen offset:1024 nt lds
    buffer_load_dwordx4 v33, s[8:11], s32 offen offset:2048 nt lds
    s_xor_b32 s32, s30, 7
    s_lshl_b32 s33, s32, 1
    s_sub_u32 s33, 34, s33
    s_lshr_b64 s[62:63], s[60:61], s33
    s_lshl_b32 s32, s32, 10
    s_add_u32 s37, s29, s32
    s_lshl_b32 s32, s32, 1
    s_add_u32 s47, s28, s32
    v_bfe_u32 v34, s62, 0, 2
    v_bfe_u32 v35, s62, 0, 2
    v_bfe_u32 v36, s62, v170, 2
    v_lshl_add_u32 v34, v34, 15, v1
    v_lshl_add_u32 v35, v35, 15, v2
    v_lshl_add_u32 v36, v36, 15, v3
    v_bfe_u32 v37, s62, 2, 2
    v_bfe_u32 v38, s62, v171, 2
    v_bfe_u32 v39, s62, 4, 2
    v_lshl_add_u32 v37, v37, 15, v174
    v_lshl_add_u32 v38, v38, 15, v175
    v_lshl_add_u32 v39, v39, 15, v176
    v_bfe_u32 v12, s62, 0, 2
    v_bfe_u32 v13, s62, v167, 2
    v_bfe_u32 v14, s62, v168, 2
    s_mov_b32 m0, 46080
    v_lshl_add_u32 v12, v12, 14, v164
    v_lshl_add_u32 v13, v13, 14, v165
    v_lshl_add_u32 v14, v14, 14, v166
    buffer_load_dwordx4 v12, s[12:15], s37 offen offset:0 nt lds
    buffer_load_dwordx4 v13, s[12:15], s37 offen offset:1024 nt lds
    buffer_load_dwordx4 v14, s[12:15], s37 offen offset:2048 nt lds
    s_mov_b32 m0, 49152
    s_add_u32 s32, s47, 0
    buffer_load_dwordx4 v34, s[8:11], s32 offen offset:0 nt lds
    buffer_load_dwordx4 v35, s[8:11], s32 offen offset:1024 nt lds
    buffer_load_dwordx4 v36, s[8:11], s32 offen offset:2048 nt lds
    s_waitcnt vmcnt(36)
    v_mov_b32 v6, 2
    ds_write_b32 v5, v6 offset:0
    s_mov_b32 m0, 55296
    s_add_u32 s32, s47, 98304
    buffer_load_dwordx4 v34, s[8:11], s32 offen offset:0 nt lds
    buffer_load_dwordx4 v35, s[8:11], s32 offen offset:1024 nt lds
    buffer_load_dwordx4 v36, s[8:11], s32 offen offset:2048 nt lds
    s_mov_b32 m0, 52224
    s_add_u32 s32, s47, 0
    buffer_load_dwordx4 v37, s[8:11], s32 offen offset:0 nt lds
    buffer_load_dwordx4 v38, s[8:11], s32 offen offset:1024 nt lds
    buffer_load_dwordx4 v39, s[8:11], s32 offen offset:2048 nt lds
    s_mov_b32 m0, 58368
    s_add_u32 s32, s47, 98304
    buffer_load_dwordx4 v37, s[8:11], s32 offen offset:0 nt lds
    buffer_load_dwordx4 v38, s[8:11], s32 offen offset:1024 nt lds
    buffer_load_dwordx4 v39, s[8:11], s32 offen offset:2048 nt lds
    s_xor_b32 s32, s30, 8
    s_lshl_b32 s33, s32, 1
    s_sub_u32 s33, 34, s33
    s_lshr_b64 s[62:63], s[60:61], s33
    s_lshl_b32 s32, s32, 10
    s_add_u32 s37, s29, s32
    s_lshl_b32 s32, s32, 1
    s_add_u32 s48, s28, s32
    v_bfe_u32 v40, s62, 0, 2
    v_bfe_u32 v41, s62, 0, 2
    v_bfe_u32 v42, s62, v170, 2
    v_lshl_add_u32 v40, v40, 15, v1
    v_lshl_add_u32 v41, v41, 15, v2
    v_lshl_add_u32 v42, v42, 15, v3
    v_bfe_u32 v43, s62, 2, 2
    v_bfe_u32 v44, s62, v171, 2
    v_bfe_u32 v45, s62, 4, 2
    v_lshl_add_u32 v43, v43, 15, v174
    v_lshl_add_u32 v44, v44, 15, v175
    v_lshl_add_u32 v45, v45, 15, v176
    v_bfe_u32 v12, s62, 0, 2
    v_bfe_u32 v13, s62, v167, 2
    v_bfe_u32 v14, s62, v168, 2
    s_mov_b32 m0, 61440
    v_lshl_add_u32 v12, v12, 14, v164
    v_lshl_add_u32 v13, v13, 14, v165
    v_lshl_add_u32 v14, v14, 14, v166
    buffer_load_dwordx4 v12, s[12:15], s37 offen offset:0 nt lds
    buffer_load_dwordx4 v13, s[12:15], s37 offen offset:1024 nt lds
    buffer_load_dwordx4 v14, s[12:15], s37 offen offset:2048 nt lds
    s_waitcnt vmcnt(36)
    v_mov_b32 v6, 6
    ds_write_b32 v5, v6 offset:0
    s_mov_b32 m0, 64512
    s_add_u32 s32, s48, 0
    buffer_load_dwordx4 v40, s[8:11], s32 offen offset:0 nt lds
    buffer_load_dwordx4 v41, s[8:11], s32 offen offset:1024 nt lds
    buffer_load_dwordx4 v42, s[8:11], s32 offen offset:2048 nt lds
    s_mov_b32 m0, 70656
    s_add_u32 s32, s48, 98304
    buffer_load_dwordx4 v40, s[8:11], s32 offen offset:0 nt lds
    buffer_load_dwordx4 v41, s[8:11], s32 offen offset:1024 nt lds
    buffer_load_dwordx4 v42, s[8:11], s32 offen offset:2048 nt lds
    s_mov_b32 m0, 67584
    s_add_u32 s32, s48, 0
    buffer_load_dwordx4 v43, s[8:11], s32 offen offset:0 nt lds
    buffer_load_dwordx4 v44, s[8:11], s32 offen offset:1024 nt lds
    buffer_load_dwordx4 v45, s[8:11], s32 offen offset:2048 nt lds
    s_mov_b32 m0, 73728
    s_add_u32 s32, s48, 98304
    buffer_load_dwordx4 v43, s[8:11], s32 offen offset:0 nt lds
    buffer_load_dwordx4 v44, s[8:11], s32 offen offset:1024 nt lds
    buffer_load_dwordx4 v45, s[8:11], s32 offen offset:2048 nt lds
L_gate5:
    ds_read_b64 v[172:173], v5 offset:8
    s_waitcnt lgkmcnt(0)
    v_readfirstlane_b32 s31, v173
    s_cmp_eq_u32 s31, 0
    s_cbranch_scc1 L_gate5
    s_add_u32 s32, s28, 98304
    s_lshr_b32 s32, s32, 21
    s_xor_b32 s32, s32, s31
    s_and_b32 s32, s32, 1
    s_lshl_b32 s32, s32, 2
    s_xor_b32 s7, s30, s32
    s_xor_b32 s32, s7, 9
    s_lshl_b32 s33, s32, 1
    s_sub_u32 s33, 34, s33
    s_lshr_b64 s[62:63], s[60:61], s33
    s_lshl_b32 s32, s32, 10
    s_add_u32 s37, s29, s32
    s_lshl_b32 s32, s32, 1
    s_add_u32 s49, s28, s32
    v_bfe_u32 v46, s62, 0, 2
    v_bfe_u32 v47, s62, 0, 2
    v_bfe_u32 v48, s62, v170, 2
    v_lshl_add_u32 v46, v46, 15, v1
    v_lshl_add_u32 v47, v47, 15, v2
    v_lshl_add_u32 v48, v48, 15, v3
    v_bfe_u32 v49, s62, 2, 2
    v_bfe_u32 v50, s62, v171, 2
    v_bfe_u32 v51, s62, 4, 2
    v_lshl_add_u32 v49, v49, 15, v174
    v_lshl_add_u32 v50, v50, 15, v175
    v_lshl_add_u32 v51, v51, 15, v176
    v_bfe_u32 v12, s62, 0, 2
    v_bfe_u32 v13, s62, v167, 2
    v_bfe_u32 v14, s62, v168, 2
    s_mov_b32 m0, 76800
    v_lshl_add_u32 v12, v12, 14, v164
    v_lshl_add_u32 v13, v13, 14, v165
    v_lshl_add_u32 v14, v14, 14, v166
    buffer_load_dwordx4 v12, s[12:15], s37 offen offset:0 nt lds
    buffer_load_dwordx4 v13, s[12:15], s37 offen offset:1024 nt lds
    buffer_load_dwordx4 v14, s[12:15], s37 offen offset:2048 nt lds
    s_mov_b32 m0, 79872
    s_add_u32 s32, s49, 0
    buffer_load_dwordx4 v46, s[8:11], s32 offen offset:0 nt lds
    buffer_load_dwordx4 v47, s[8:11], s32 offen offset:1024 nt lds
    buffer_load_dwordx4 v48, s[8:11], s32 offen offset:2048 nt lds
    s_mov_b32 m0, 86016
    s_add_u32 s32, s49, 98304
    buffer_load_dwordx4 v46, s[8:11], s32 offen offset:0 nt lds
    buffer_load_dwordx4 v47, s[8:11], s32 offen offset:1024 nt lds
    buffer_load_dwordx4 v48, s[8:11], s32 offen offset:2048 nt lds
    s_waitcnt vmcnt(54)
    v_mov_b32 v6, 9
    ds_write_b32 v5, v6 offset:0
    s_mov_b32 m0, 82944
    s_add_u32 s32, s49, 0
    buffer_load_dwordx4 v49, s[8:11], s32 offen offset:0 nt lds
    buffer_load_dwordx4 v50, s[8:11], s32 offen offset:1024 nt lds
    buffer_load_dwordx4 v51, s[8:11], s32 offen offset:2048 nt lds
    s_mov_b32 m0, 89088
    s_add_u32 s32, s49, 98304
    buffer_load_dwordx4 v49, s[8:11], s32 offen offset:0 nt lds
    buffer_load_dwordx4 v50, s[8:11], s32 offen offset:1024 nt lds
    buffer_load_dwordx4 v51, s[8:11], s32 offen offset:2048 nt lds
    s_xor_b32 s32, s7, 10
    s_lshl_b32 s33, s32, 1
    s_sub_u32 s33, 34, s33
    s_lshr_b64 s[62:63], s[60:61], s33
    s_lshl_b32 s32, s32, 10
    s_add_u32 s37, s29, s32
    s_lshl_b32 s32, s32, 1
    s_add_u32 s50, s28, s32
    v_bfe_u32 v52, s62, 0, 2
    v_bfe_u32 v53, s62, 0, 2
    v_bfe_u32 v54, s62, v170, 2
    v_lshl_add_u32 v52, v52, 15, v1
    v_lshl_add_u32 v53, v53, 15, v2
    v_lshl_add_u32 v54, v54, 15, v3
    v_bfe_u32 v55, s62, 2, 2
    v_bfe_u32 v56, s62, v171, 2
    v_bfe_u32 v57, s62, 4, 2
    v_lshl_add_u32 v55, v55, 15, v174
    v_lshl_add_u32 v56, v56, 15, v175
    v_lshl_add_u32 v57, v57, 15, v176
    v_bfe_u32 v12, s62, 0, 2
    v_bfe_u32 v13, s62, v167, 2
    v_bfe_u32 v14, s62, v168, 2
    s_mov_b32 m0, 92160
    v_lshl_add_u32 v12, v12, 14, v164
    v_lshl_add_u32 v13, v13, 14, v165
    v_lshl_add_u32 v14, v14, 14, v166
    buffer_load_dwordx4 v12, s[12:15], s37 offen offset:0 nt lds
    buffer_load_dwordx4 v13, s[12:15], s37 offen offset:1024 nt lds
    buffer_load_dwordx4 v14, s[12:15], s37 offen offset:2048 nt lds
    s_mov_b32 m0, 95232
    s_add_u32 s32, s50, 0
    buffer_load_dwordx4 v52, s[8:11], s32 offen offset:0 nt lds
    buffer_load_dwordx4 v53, s[8:11], s32 offen offset:1024 nt lds
    buffer_load_dwordx4 v54, s[8:11], s32 offen offset:2048 nt lds
    s_mov_b32 m0, 101376
    s_add_u32 s32, s50, 98304
    buffer_load_dwordx4 v52, s[8:11], s32 offen offset:0 nt lds
    buffer_load_dwordx4 v53, s[8:11], s32 offen offset:1024 nt lds
    buffer_load_dwordx4 v54, s[8:11], s32 offen offset:2048 nt lds
    s_waitcnt vmcnt(54)
    v_mov_b32 v6, 12
    ds_write_b32 v5, v6 offset:0
    s_mov_b32 m0, 98304
    s_add_u32 s32, s50, 0
    buffer_load_dwordx4 v55, s[8:11], s32 offen offset:0 nt lds
    buffer_load_dwordx4 v56, s[8:11], s32 offen offset:1024 nt lds
    buffer_load_dwordx4 v57, s[8:11], s32 offen offset:2048 nt lds
    s_mov_b32 m0, 104448
    s_add_u32 s32, s50, 98304
    buffer_load_dwordx4 v55, s[8:11], s32 offen offset:0 nt lds
    buffer_load_dwordx4 v56, s[8:11], s32 offen offset:1024 nt lds
    buffer_load_dwordx4 v57, s[8:11], s32 offen offset:2048 nt lds
    s_xor_b32 s32, s7, 11
    s_lshl_b32 s33, s32, 1
    s_sub_u32 s33, 34, s33
    s_lshr_b64 s[62:63], s[60:61], s33
    s_lshl_b32 s32, s32, 10
    s_add_u32 s37, s29, s32
    s_lshl_b32 s32, s32, 1
    s_add_u32 s51, s28, s32
    v_bfe_u32 v58, s62, 0, 2
    v_bfe_u32 v59, s62, 0, 2
    v_bfe_u32 v60, s62, v170, 2
    v_lshl_add_u32 v58, v58, 15, v1
    v_lshl_add_u32 v59, v59, 15, v2
    v_lshl_add_u32 v60, v60, 15, v3
    v_bfe_u32 v61, s62, 2, 2
    v_bfe_u32 v62, s62, v171, 2
    v_bfe_u32 v63, s62, 4, 2
    v_lshl_add_u32 v61, v61, 15, v174
    v_lshl_add_u32 v62, v62, 15, v175
    v_lshl_add_u32 v63, v63, 15, v176
    v_bfe_u32 v12, s62, 0, 2
    v_bfe_u32 v13, s62, v167, 2
    v_bfe_u32 v14, s62, v168, 2
    s_mov_b32 m0, 107520
    v_lshl_add_u32 v12, v12, 14, v164
    v_lshl_add_u32 v13, v13, 14, v165
    v_lshl_add_u32 v14, v14, 14, v166
    buffer_load_dwordx4 v12, s[12:15], s37 offen offset:0 nt lds
    buffer_load_dwordx4 v13, s[12:15], s37 offen offset:1024 nt lds
    buffer_load_dwordx4 v14, s[12:15], s37 offen offset:2048 nt lds
    s_mov_b32 m0, 110592
    s_add_u32 s32, s51, 0
    buffer_load_dwordx4 v58, s[8:11], s32 offen offset:0 nt lds
    buffer_load_dwordx4 v59, s[8:11], s32 offen offset:1024 nt lds
    buffer_load_dwordx4 v60, s[8:11], s32 offen offset:2048 nt lds
    ds_read_b32 v160, v5 offset:16
    ds_read_b128 v[112:115], v4 offset:3072
    ds_read_b128 v[116:119], v4 offset:4096
    ds_read_b128 v[120:123], v4 offset:5120
    ds_read_b128 v[124:127], v4 offset:6144
    ds_read_b128 v[128:131], v4 offset:7168
    ds_read_b128 v[132:135], v4 offset:8192
    s_branch L_chk0
L_retry0:
    s_sleep 1
    ds_read_b32 v160, v5 offset:16
    s_waitcnt lgkmcnt(0)
    v_readfirstlane_b32 s32, v160
    s_cmp_gt_u32 s32, 0
    s_cbranch_scc0 L_retry0
    ds_read_b32 v160, v5 offset:16
    ds_read_b128 v[112:115], v4 offset:3072
    ds_read_b128 v[116:119], v4 offset:4096
    ds_read_b128 v[120:123], v4 offset:5120
    ds_read_b128 v[124:127], v4 offset:6144
    ds_read_b128 v[128:131], v4 offset:7168
    ds_read_b128 v[132:135], v4 offset:8192
L_chk0:
    s_waitcnt lgkmcnt(0)
    v_readfirstlane_b32 s32, v160
    s_cmp_gt_u32 s32, 0
    s_cbranch_scc0 L_retry0
    ds_read_b32 v162, v5 offset:16
    ds_read_b128 v[136:139], v4 offset:9216
    ds_read_b128 v[140:143], v4 offset:10240
    ds_read_b128 v[144:147], v4 offset:11264
    ds_read_b128 v[148:151], v4 offset:12288
    ds_read_b128 v[152:155], v4 offset:13312
    ds_read_b128 v[156:159], v4 offset:14336
    s_add_u32 s36, s44, 0
    buffer_store_dwordx4 v[112:115], v16, s[16:19], s36 offen offset:0 sc1
    buffer_store_dwordx4 v[116:119], v17, s[16:19], s36 offen offset:1024 sc1
    buffer_store_dwordx4 v[120:123], v18, s[16:19], s36 offen offset:2048 sc1
    s_waitcnt vmcnt(54)
    v_mov_b32 v6, 15
    ds_write_b32 v5, v6 offset:0
    s_mov_b32 m0, 116736
    s_add_u32 s32, s51, 98304
    buffer_load_dwordx4 v58, s[8:11], s32 offen offset:0 nt lds
    buffer_load_dwordx4 v59, s[8:11], s32 offen offset:1024 nt lds
    buffer_load_dwordx4 v60, s[8:11], s32 offen offset:2048 nt lds
    s_add_u32 s36, s44, 0
    buffer_store_dwordx4 v[124:127], v19, s[16:19], s36 offen offset:0 sc1
    buffer_store_dwordx4 v[128:131], v20, s[16:19], s36 offen offset:1024 sc1
    buffer_store_dwordx4 v[132:135], v21, s[16:19], s36 offen offset:2048 sc1
    s_branch L_chk1
L_retry1:
    s_sleep 1
    ds_read_b32 v162, v5 offset:16
    s_waitcnt lgkmcnt(0)
    v_readfirstlane_b32 s32, v162
    s_cmp_gt_u32 s32, 1
    s_cbranch_scc0 L_retry1
    ds_read_b32 v162, v5 offset:16
    ds_read_b128 v[136:139], v4 offset:9216
    ds_read_b128 v[140:143], v4 offset:10240
    ds_read_b128 v[144:147], v4 offset:11264
    ds_read_b128 v[148:151], v4 offset:12288
    ds_read_b128 v[152:155], v4 offset:13312
    ds_read_b128 v[156:159], v4 offset:14336
L_chk1:
    s_waitcnt lgkmcnt(0)
    v_readfirstlane_b32 s32, v162
    s_cmp_gt_u32 s32, 1
    s_cbranch_scc0 L_retry1
    ds_read_b32 v160, v5 offset:20
    ds_read_b128 v[112:115], v4 offset:18432
    ds_read_b128 v[116:119], v4 offset:19456
    ds_read_b128 v[120:123], v4 offset:20480
    ds_read_b128 v[124:127], v4 offset:21504
    ds_read_b128 v[128:131], v4 offset:22528
    ds_read_b128 v[132:135], v4 offset:23552
    s_add_u32 s36, s44, 98304
    buffer_store_dwordx4 v[136:139], v16, s[16:19], s36 offen offset:0 sc1
    buffer_store_dwordx4 v[140:143], v17, s[16:19], s36 offen offset:1024 sc1
    buffer_store_dwordx4 v[144:147], v18, s[16:19], s36 offen offset:2048 sc1
    s_mov_b32 m0, 113664
    s_add_u32 s32, s51, 0
    buffer_load_dwordx4 v61, s[8:11], s32 offen offset:0 nt lds
    buffer_load_dwordx4 v62, s[8:11], s32 offen offset:1024 nt lds
    buffer_load_dwordx4 v63, s[8:11], s32 offen offset:2048 nt lds
    s_add_u32 s36, s44, 98304
    buffer_store_dwordx4 v[148:151], v19, s[16:19], s36 offen offset:0 sc1
    buffer_store_dwordx4 v[152:155], v20, s[16:19], s36 offen offset:1024 sc1
    buffer_store_dwordx4 v[156:159], v21, s[16:19], s36 offen offset:2048 sc1
    s_mov_b32 m0, 119808
    s_add_u32 s32, s51, 98304
    buffer_load_dwordx4 v61, s[8:11], s32 offen offset:0 nt lds
    buffer_load_dwordx4 v62, s[8:11], s32 offen offset:1024 nt lds
    buffer_load_dwordx4 v63, s[8:11], s32 offen offset:2048 nt lds
L_chk2:
    s_waitcnt lgkmcnt(0)
    v_readfirstlane_b32 s32, v160
    s_cmp_gt_u32 s32, 2
    s_cbranch_scc0 L_retry2
    ds_read_b32 v162, v5 offset:20
    ds_read_b128 v[136:139], v4 offset:24576
    ds_read_b128 v[140:143], v4 offset:25600
    ds_read_b128 v[144:147], v4 offset:26624
    ds_read_b128 v[148:151], v4 offset:27648
    ds_read_b128 v[152:155], v4 offset:28672
    ds_read_b128 v[156:159], v4 offset:29696
    s_add_u32 s36, s45, 0
    buffer_store_dwordx4 v[112:115], v22, s[16:19], s36 offen offset:0 sc1
    buffer_store_dwordx4 v[116:119], v23, s[16:19], s36 offen offset:1024 sc1
    buffer_store_dwordx4 v[120:123], v24, s[16:19], s36 offen offset:2048 sc1
    s_waitcnt vmcnt(60)
    v_mov_b32 v6, 18
    ds_write_b32 v5, v6 offset:0
    s_add_u32 s36, s45, 0
    buffer_store_dwordx4 v[124:127], v25, s[16:19], s36 offen offset:0 sc1
    buffer_store_dwordx4 v[128:131], v26, s[16:19], s36 offen offset:1024 sc1
    buffer_store_dwordx4 v[132:135], v27, s[16:19], s36 offen offset:2048 sc1
L_gate8:
    ds_read_b64 v[172:173], v5 offset:8
    s_waitcnt lgkmcnt(0)
    v_readfirstlane_b32 s32, v172
    s_cmp_lt_u32 s32, 4
    s_cbranch_scc1 L_gate8
    s_lshl_b32 s39, s39, 1
    s_sub_u32 s39, 49152, s39
    s_add_u32 s29, s29, s39
    s_lshl_b32 s28, s29, 2
    s_add_u32 s32, s28, 98304
    s_lshr_b32 s32, s32, 21
    s_xor_b32 s32, s32, s31
    s_and_b32 s32, s32, 1
    s_lshl_b32 s32, s32, 2
    s_xor_b32 s7, s30, s32
    s_xor_b32 s32, s7, 0
    s_lshl_b32 s33, s32, 1
    s_sub_u32 s33, 34, s33
    s_lshr_b64 s[62:63], s[60:61], s33
    s_lshl_b32 s32, s32, 10
    s_add_u32 s37, s29, s32
    s_lshl_b32 s32, s32, 1
    s_add_u32 s52, s28, s32
    v_bfe_u32 v64, s62, 0, 2
    v_bfe_u32 v65, s62, 0, 2
    v_bfe_u32 v66, s62, v170, 2
    v_lshl_add_u32 v64, v64, 15, v1
    v_lshl_add_u32 v65, v65, 15, v2
    v_lshl_add_u32 v66, v66, 15, v3
    v_bfe_u32 v67, s62, 2, 2
    v_bfe_u32 v68, s62, v171, 2
    v_bfe_u32 v69, s62, 4, 2
    v_lshl_add_u32 v67, v67, 15, v174
    v_lshl_add_u32 v68, v68, 15, v175
    v_lshl_add_u32 v69, v69, 15, v176
    v_bfe_u32 v12, s62, 0, 2
    v_bfe_u32 v13, s62, v167, 2
    v_bfe_u32 v14, s62, v168, 2
    s_mov_b32 m0, 122880
    v_lshl_add_u32 v12, v12, 14, v164
    v_lshl_add_u32 v13, v13, 14, v165
    v_lshl_add_u32 v14, v14, 14, v166
    buffer_load_dwordx4 v12, s[12:15], s37 offen offset:0 nt lds
    buffer_load_dwordx4 v13, s[12:15], s37 offen offset:1024 nt lds
    buffer_load_dwordx4 v14, s[12:15], s37 offen offset:2048 nt lds
L_chk3:
    s_waitcnt lgkmcnt(0)
    v_readfirstlane_b32 s32, v162
    s_cmp_gt_u32 s32, 3
    s_cbranch_scc0 L_retry3
    ds_read_b32 v160, v5 offset:24
    ds_read_b128 v[112:115], v4 offset:33792
    ds_read_b128 v[116:119], v4 offset:34816
    ds_read_b128 v[120:123], v4 offset:35840
    ds_read_b128 v[124:127], v4 offset:36864
    ds_read_b128 v[128:131], v4 offset:37888
    ds_read_b128 v[132:135], v4 offset:38912
    s_add_u32 s36, s45, 98304
    buffer_store_dwordx4 v[136:139], v22, s[16:19], s36 offen offset:0 sc1
    buffer_store_dwordx4 v[140:143], v23, s[16:19], s36 offen offset:1024 sc1
    buffer_store_dwordx4 v[144:147], v24, s[16:19], s36 offen offset:2048 sc1
    s_mov_b32 m0, 125952
    s_add_u32 s32, s52, 0
    buffer_load_dwordx4 v64, s[8:11], s32 offen offset:0 nt lds
    buffer_load_dwordx4 v65, s[8:11], s32 offen offset:1024 nt lds
    buffer_load_dwordx4 v66, s[8:11], s32 offen offset:2048 nt lds
    s_add_u32 s36, s45, 98304
    buffer_store_dwordx4 v[148:151], v25, s[16:19], s36 offen offset:0 sc1
    buffer_store_dwordx4 v[152:155], v26, s[16:19], s36 offen offset:1024 sc1
    buffer_store_dwordx4 v[156:159], v27, s[16:19], s36 offen offset:2048 sc1
    s_mov_b32 m0, 132096
    s_add_u32 s32, s52, 98304
    buffer_load_dwordx4 v64, s[8:11], s32 offen offset:0 nt lds
    buffer_load_dwordx4 v65, s[8:11], s32 offen offset:1024 nt lds
    buffer_load_dwordx4 v66, s[8:11], s32 offen offset:2048 nt lds
L_chk4:
    s_waitcnt lgkmcnt(0)
    v_readfirstlane_b32 s32, v160
    s_cmp_gt_u32 s32, 4
    s_cbranch_scc0 L_retry4
    ds_read_b32 v162, v5 offset:24
    ds_read_b128 v[136:139], v4 offset:39936
    ds_read_b128 v[140:143], v4 offset:40960
    ds_read_b128 v[144:147], v4 offset:41984
    ds_read_b128 v[148:151], v4 offset:43008
    ds_read_b128 v[152:155], v4 offset:44032
    ds_read_b128 v[156:159], v4 offset:45056
    s_add_u32 s36, s46, 0
    buffer_store_dwordx4 v[112:115], v28, s[16:19], s36 offen offset:0 sc1
    buffer_store_dwordx4 v[116:119], v29, s[16:19], s36 offen offset:1024 sc1
    buffer_store_dwordx4 v[120:123], v30, s[16:19], s36 offen offset:2048 sc1
    s_waitcnt vmcnt(63)
    v_mov_b32 v6, 21
    ds_write_b32 v5, v6 offset:0
    s_add_u32 s36, s46, 0
    buffer_store_dwordx4 v[124:127], v31, s[16:19], s36 offen offset:0 sc1
    buffer_store_dwordx4 v[128:131], v32, s[16:19], s36 offen offset:1024 sc1
    buffer_store_dwordx4 v[132:135], v33, s[16:19], s36 offen offset:2048 sc1
    s_mov_b32 m0, 129024
    s_add_u32 s32, s52, 0
    buffer_load_dwordx4 v67, s[8:11], s32 offen offset:0 nt lds
    buffer_load_dwordx4 v68, s[8:11], s32 offen offset:1024 nt lds
    buffer_load_dwordx4 v69, s[8:11], s32 offen offset:2048 nt lds
L_chk5:
    s_waitcnt lgkmcnt(0)
    v_readfirstlane_b32 s32, v162
    s_cmp_gt_u32 s32, 5
    s_cbranch_scc0 L_retry5
    ds_read_b32 v160, v5 offset:28
    ds_read_b128 v[112:115], v4 offset:49152
    ds_read_b128 v[116:119], v4 offset:50176
    ds_read_b128 v[120:123], v4 offset:51200
    ds_read_b128 v[124:127], v4 offset:52224
    ds_read_b128 v[128:131], v4 offset:53248
    ds_read_b128 v[132:135], v4 offset:54272
    s_add_u32 s36, s46, 98304
    buffer_store_dwordx4 v[136:139], v28, s[16:19], s36 offen offset:0 sc1
    buffer_store_dwordx4 v[140:143], v29, s[16:19], s36 offen offset:1024 sc1
    buffer_store_dwordx4 v[144:147], v30, s[16:19], s36 offen offset:2048 sc1
    s_mov_b32 m0, 135168
    s_add_u32 s32, s52, 98304
    buffer_load_dwordx4 v67, s[8:11], s32 offen offset:0 nt lds
    buffer_load_dwordx4 v68, s[8:11], s32 offen offset:1024 nt lds
    buffer_load_dwordx4 v69, s[8:11], s32 offen offset:2048 nt lds
    s_add_u32 s36, s46, 98304
    buffer_store_dwordx4 v[148:151], v31, s[16:19], s36 offen offset:0 sc1
    buffer_store_dwordx4 v[152:155], v32, s[16:19], s36 offen offset:1024 sc1
    buffer_store_dwordx4 v[156:159], v33, s[16:19], s36 offen offset:2048 sc1
    s_xor_b32 s32, s7, 1
    s_lshl_b32 s33, s32, 1
    s_sub_u32 s33, 34, s33
    s_lshr_b64 s[62:63], s[60:61], s33
    s_lshl_b32 s32, s32, 10
    s_add_u32 s37, s29, s32
    s_lshl_b32 s32, s32, 1
    s_add_u32 s53, s28, s32
    v_bfe_u32 v70, s62, 0, 2
    v_bfe_u32 v71, s62, 0, 2
    v_bfe_u32 v72, s62, v170, 2
    v_lshl_add_u32 v70, v70, 15, v1
    v_lshl_add_u32 v71, v71, 15, v2
    v_lshl_add_u32 v72, v72, 15, v3
    v_bfe_u32 v73, s62, 2, 2
    v_bfe_u32 v74, s62, v171, 2
    v_bfe_u32 v75, s62, 4, 2
    v_lshl_add_u32 v73, v73, 15, v174
    v_lshl_add_u32 v74, v74, 15, v175
    v_lshl_add_u32 v75, v75, 15, v176
    v_bfe_u32 v12, s62, 0, 2
    v_bfe_u32 v13, s62, v167, 2
    v_bfe_u32 v14, s62, v168, 2
    s_mov_b32 m0, 0
    v_lshl_add_u32 v12, v12, 14, v164
    v_lshl_add_u32 v13, v13, 14, v165
    v_lshl_add_u32 v14, v14, 14, v166
    buffer_load_dwordx4 v12, s[12:15], s37 offen offset:0 nt lds
    buffer_load_dwordx4 v13, s[12:15], s37 offen offset:1024 nt lds
    buffer_load_dwordx4 v14, s[12:15], s37 offen offset:2048 nt lds
L_chk6:
    s_waitcnt lgkmcnt(0)
    v_readfirstlane_b32 s32, v160
    s_cmp_gt_u32 s32, 6
    s_cbranch_scc0 L_retry6
    ds_read_b32 v162, v5 offset:28
    ds_read_b128 v[136:139], v4 offset:55296
    ds_read_b128 v[140:143], v4 offset:56320
    ds_read_b128 v[144:147], v4 offset:57344
    ds_read_b128 v[148:151], v4 offset:58368
    ds_read_b128 v[152:155], v4 offset:59392
    ds_read_b128 v[156:159], v4 offset:60416
    s_add_u32 s36, s47, 0
    buffer_store_dwordx4 v[112:115], v34, s[16:19], s36 offen offset:0 sc1
    buffer_store_dwordx4 v[116:119], v35, s[16:19], s36 offen offset:1024 sc1
    buffer_store_dwordx4 v[120:123], v36, s[16:19], s36 offen offset:2048 sc1
    s_waitcnt vmcnt(63)
    v_mov_b32 v6, 24
    ds_write_b32 v5, v6 offset:0
    s_add_u32 s36, s47, 0
    buffer_store_dwordx4 v[124:127], v37, s[16:19], s36 offen offset:0 sc1
    buffer_store_dwordx4 v[128:131], v38, s[16:19], s36 offen offset:1024 sc1
    buffer_store_dwordx4 v[132:135], v39, s[16:19], s36 offen offset:2048 sc1
    s_mov_b32 m0, 3072
    s_add_u32 s32, s53, 0
    buffer_load_dwordx4 v70, s[8:11], s32 offen offset:0 nt lds
    buffer_load_dwordx4 v71, s[8:11], s32 offen offset:1024 nt lds
    buffer_load_dwordx4 v72, s[8:11], s32 offen offset:2048 nt lds
L_chk7:
    s_waitcnt lgkmcnt(0)
    v_readfirstlane_b32 s32, v162
    s_cmp_gt_u32 s32, 7
    s_cbranch_scc0 L_retry7
    ds_read_b32 v160, v5 offset:16
    ds_read_b128 v[112:115], v9 offset:3072
    ds_read_b128 v[116:119], v9 offset:4096
    ds_read_b128 v[120:123], v9 offset:5120
    ds_read_b128 v[124:127], v9 offset:6144
    ds_read_b128 v[128:131], v9 offset:7168
    ds_read_b128 v[132:135], v9 offset:8192
    s_add_u32 s36, s47, 98304
    buffer_store_dwordx4 v[136:139], v34, s[16:19], s36 offen offset:0 sc1
    buffer_store_dwordx4 v[140:143], v35, s[16:19], s36 offen offset:1024 sc1
    buffer_store_dwordx4 v[144:147], v36, s[16:19], s36 offen offset:2048 sc1
    s_mov_b32 m0, 9216
    s_add_u32 s32, s53, 98304
    buffer_load_dwordx4 v70, s[8:11], s32 offen offset:0 nt lds
    buffer_load_dwordx4 v71, s[8:11], s32 offen offset:1024 nt lds
    buffer_load_dwordx4 v72, s[8:11], s32 offen offset:2048 nt lds
    s_add_u32 s36, s47, 98304
    buffer_store_dwordx4 v[148:151], v37, s[16:19], s36 offen offset:0 sc1
    buffer_store_dwordx4 v[152:155], v38, s[16:19], s36 offen offset:1024 sc1
    buffer_store_dwordx4 v[156:159], v39, s[16:19], s36 offen offset:2048 sc1
    s_mov_b32 m0, 6144
    s_add_u32 s32, s53, 0
    buffer_load_dwordx4 v73, s[8:11], s32 offen offset:0 nt lds
    buffer_load_dwordx4 v74, s[8:11], s32 offen offset:1024 nt lds
    buffer_load_dwordx4 v75, s[8:11], s32 offen offset:2048 nt lds
L_chk8:
    s_waitcnt lgkmcnt(0)
    v_readfirstlane_b32 s32, v160
    s_cmp_gt_u32 s32, 8
    s_cbranch_scc0 L_retry8
    ds_read_b32 v162, v5 offset:16
    ds_read_b128 v[136:139], v9 offset:9216
    ds_read_b128 v[140:143], v9 offset:10240
    ds_read_b128 v[144:147], v9 offset:11264
    ds_read_b128 v[148:151], v9 offset:12288
    ds_read_b128 v[152:155], v9 offset:13312
    ds_read_b128 v[156:159], v9 offset:14336
    s_add_u32 s36, s48, 0
    buffer_store_dwordx4 v[112:115], v40, s[16:19], s36 offen offset:0 sc1
    buffer_store_dwordx4 v[116:119], v41, s[16:19], s36 offen offset:1024 sc1
    buffer_store_dwordx4 v[120:123], v42, s[16:19], s36 offen offset:2048 sc1
    s_waitcnt vmcnt(63)
    v_mov_b32 v6, 27
    ds_write_b32 v5, v6 offset:0
    s_add_u32 s36, s48, 0
    buffer_store_dwordx4 v[124:127], v43, s[16:19], s36 offen offset:0 sc1
    buffer_store_dwordx4 v[128:131], v44, s[16:19], s36 offen offset:1024 sc1
    buffer_store_dwordx4 v[132:135], v45, s[16:19], s36 offen offset:2048 sc1
    s_mov_b32 m0, 12288
    s_add_u32 s32, s53, 98304
    buffer_load_dwordx4 v73, s[8:11], s32 offen offset:0 nt lds
    buffer_load_dwordx4 v74, s[8:11], s32 offen offset:1024 nt lds
    buffer_load_dwordx4 v75, s[8:11], s32 offen offset:2048 nt lds
L_chk9:
    s_waitcnt lgkmcnt(0)
    v_readfirstlane_b32 s32, v162
    s_cmp_gt_u32 s32, 9
    s_cbranch_scc0 L_retry9
    ds_read_b32 v160, v5 offset:20
    ds_read_b128 v[112:115], v9 offset:18432
    ds_read_b128 v[116:119], v9 offset:19456
    ds_read_b128 v[120:123], v9 offset:20480
    ds_read_b128 v[124:127], v9 offset:21504
    ds_read_b128 v[128:131], v9 offset:22528
    ds_read_b128 v[132:135], v9 offset:23552
    s_add_u32 s36, s48, 98304
    buffer_store_dwordx4 v[136:139], v40, s[16:19], s36 offen offset:0 sc1
    buffer_store_dwordx4 v[140:143], v41, s[16:19], s36 offen offset:1024 sc1
    buffer_store_dwordx4 v[144:147], v42, s[16:19], s36 offen offset:2048 sc1
    s_xor_b32 s32, s7, 2
    s_lshl_b32 s33, s32, 1
    s_sub_u32 s33, 34, s33
    s_lshr_b64 s[62:63], s[60:61], s33
    s_lshl_b32 s32, s32, 10
    s_add_u32 s37, s29, s32
    s_lshl_b32 s32, s32, 1
    s_add_u32 s54, s28, s32
    v_bfe_u32 v76, s62, 0, 2
    v_bfe_u32 v77, s62, 0, 2
    v_bfe_u32 v78, s62, v170, 2
    v_lshl_add_u32 v76, v76, 15, v1
    v_lshl_add_u32 v77, v77, 15, v2
    v_lshl_add_u32 v78, v78, 15, v3
    v_bfe_u32 v79, s62, 2, 2
    v_bfe_u32 v80, s62, v171, 2
    v_bfe_u32 v81, s62, 4, 2
    v_lshl_add_u32 v79, v79, 15, v174
    v_lshl_add_u32 v80, v80, 15, v175
    v_lshl_add_u32 v81, v81, 15, v176
    v_bfe_u32 v12, s62, 0, 2
    v_bfe_u32 v13, s62, v167, 2
    v_bfe_u32 v14, s62, v168, 2
    s_mov_b32 m0, 15360
    v_lshl_add_u32 v12, v12, 14, v164
    v_lshl_add_u32 v13, v13, 14, v165
    v_lshl_add_u32 v14, v14, 14, v166
    buffer_load_dwordx4 v12, s[12:15], s37 offen offset:0 nt lds
    buffer_load_dwordx4 v13, s[12:15], s37 offen offset:1024 nt lds
    buffer_load_dwordx4 v14, s[12:15], s37 offen offset:2048 nt lds
    s_add_u32 s36, s48, 98304
    buffer_store_dwordx4 v[148:151], v43, s[16:19], s36 offen offset:0 sc1
    buffer_store_dwordx4 v[152:155], v44, s[16:19], s36 offen offset:1024 sc1
    buffer_store_dwordx4 v[156:159], v45, s[16:19], s36 offen offset:2048 sc1
    s_mov_b32 m0, 18432
    s_add_u32 s32, s54, 0
    buffer_load_dwordx4 v76, s[8:11], s32 offen offset:0 nt lds
    buffer_load_dwordx4 v77, s[8:11], s32 offen offset:1024 nt lds
    buffer_load_dwordx4 v78, s[8:11], s32 offen offset:2048 nt lds
L_chk10:
    s_waitcnt lgkmcnt(0)
    v_readfirstlane_b32 s32, v160
    s_cmp_gt_u32 s32, 10
    s_cbranch_scc0 L_retry10
    ds_read_b32 v162, v5 offset:20
    ds_read_b128 v[136:139], v9 offset:24576
    ds_read_b128 v[140:143], v9 offset:25600
    ds_read_b128 v[144:147], v9 offset:26624
    ds_read_b128 v[148:151], v9 offset:27648
    ds_read_b128 v[152:155], v9 offset:28672
    ds_read_b128 v[156:159], v9 offset:29696
    s_add_u32 s36, s49, 0
    buffer_store_dwordx4 v[112:115], v46, s[16:19], s36 offen offset:0 sc1
    buffer_store_dwordx4 v[116:119], v47, s[16:19], s36 offen offset:1024 sc1
    buffer_store_dwordx4 v[120:123], v48, s[16:19], s36 offen offset:2048 sc1
    s_waitcnt vmcnt(51)
    v_mov_b32 v6, 30
    ds_write_b32 v5, v6 offset:0
    s_add_u32 s36, s49, 0
    buffer_store_dwordx4 v[124:127], v49, s[16:19], s36 offen offset:0 sc1
    buffer_store_dwordx4 v[128:131], v50, s[16:19], s36 offen offset:1024 sc1
    buffer_store_dwordx4 v[132:135], v51, s[16:19], s36 offen offset:2048 sc1
    s_mov_b32 m0, 24576
    s_add_u32 s32, s54, 98304
    buffer_load_dwordx4 v76, s[8:11], s32 offen offset:0 nt lds
    buffer_load_dwordx4 v77, s[8:11], s32 offen offset:1024 nt lds
    buffer_load_dwordx4 v78, s[8:11], s32 offen offset:2048 nt lds
L_chk11:
    s_waitcnt lgkmcnt(0)
    v_readfirstlane_b32 s32, v162
    s_cmp_gt_u32 s32, 11
    s_cbranch_scc0 L_retry11
    ds_read_b32 v160, v5 offset:24
    ds_read_b128 v[112:115], v9 offset:33792
    ds_read_b128 v[116:119], v9 offset:34816
    ds_read_b128 v[120:123], v9 offset:35840
    ds_read_b128 v[124:127], v9 offset:36864
    ds_read_b128 v[128:131], v9 offset:37888
    ds_read_b128 v[132:135], v9 offset:38912
    s_add_u32 s36, s49, 98304
    buffer_store_dwordx4 v[136:139], v46, s[16:19], s36 offen offset:0 sc1
    buffer_store_dwordx4 v[140:143], v47, s[16:19], s36 offen offset:1024 sc1
    buffer_store_dwordx4 v[144:147], v48, s[16:19], s36 offen offset:2048 sc1
    s_mov_b32 m0, 21504
    s_add_u32 s32, s54, 0
    buffer_load_dwordx4 v79, s[8:11], s32 offen offset:0 nt lds
    buffer_load_dwordx4 v80, s[8:11], s32 offen offset:1024 nt lds
    buffer_load_dwordx4 v81, s[8:11], s32 offen offset:2048 nt lds
    s_add_u32 s36, s49, 98304
    buffer_store_dwordx4 v[148:151], v49, s[16:19], s36 offen offset:0 sc1
    buffer_store_dwordx4 v[152:155], v50, s[16:19], s36 offen offset:1024 sc1
    buffer_store_dwordx4 v[156:159], v51, s[16:19], s36 offen offset:2048 sc1
    s_mov_b32 m0, 27648
    s_add_u32 s32, s54, 98304
    buffer_load_dwordx4 v79, s[8:11], s32 offen offset:0 nt lds
    buffer_load_dwordx4 v80, s[8:11], s32 offen offset:1024 nt lds
    buffer_load_dwordx4 v81, s[8:11], s32 offen offset:2048 nt lds
L_chk12:
    s_waitcnt lgkmcnt(0)
    v_readfirstlane_b32 s32, v160
    s_cmp_gt_u32 s32, 12
    s_cbranch_scc0 L_retry12
    ds_read_b32 v162, v5 offset:24
    ds_read_b128 v[136:139], v9 offset:39936
    ds_read_b128 v[140:143], v9 offset:40960
    ds_read_b128 v[144:147], v9 offset:41984
    ds_read_b128 v[148:151], v9 offset:43008
    ds_read_b128 v[152:155], v9 offset:44032
    ds_read_b128 v[156:159], v9 offset:45056
    s_add_u32 s36, s50, 0
    buffer_store_dwordx4 v[112:115], v52, s[16:19], s36 offen offset:0 sc1
    buffer_store_dwordx4 v[116:119], v53, s[16:19], s36 offen offset:1024 sc1
    buffer_store_dwordx4 v[120:123], v54, s[16:19], s36 offen offset:2048 sc1
    s_waitcnt vmcnt(36)
    v_mov_b32 v6, 33
    ds_write_b32 v5, v6 offset:0
    s_add_u32 s36, s50, 0
    buffer_store_dwordx4 v[124:127], v55, s[16:19], s36 offen offset:0 sc1
    buffer_store_dwordx4 v[128:131], v56, s[16:19], s36 offen offset:1024 sc1
    buffer_store_dwordx4 v[132:135], v57, s[16:19], s36 offen offset:2048 sc1
    s_xor_b32 s32, s7, 3
    s_lshl_b32 s33, s32, 1
    s_sub_u32 s33, 34, s33
    s_lshr_b64 s[62:63], s[60:61], s33
    s_lshl_b32 s32, s32, 10
    s_add_u32 s37, s29, s32
    s_lshl_b32 s32, s32, 1
    s_add_u32 s55, s28, s32
    v_bfe_u32 v82, s62, 0, 2
    v_bfe_u32 v83, s62, 0, 2
    v_bfe_u32 v84, s62, v170, 2
    v_lshl_add_u32 v82, v82, 15, v1
    v_lshl_add_u32 v83, v83, 15, v2
    v_lshl_add_u32 v84, v84, 15, v3
    v_bfe_u32 v85, s62, 2, 2
    v_bfe_u32 v86, s62, v171, 2
    v_bfe_u32 v87, s62, 4, 2
    v_lshl_add_u32 v85, v85, 15, v174
    v_lshl_add_u32 v86, v86, 15, v175
    v_lshl_add_u32 v87, v87, 15, v176
    v_bfe_u32 v12, s62, 0, 2
    v_bfe_u32 v13, s62, v167, 2
    v_bfe_u32 v14, s62, v168, 2
    s_mov_b32 m0, 30720
    v_lshl_add_u32 v12, v12, 14, v164
    v_lshl_add_u32 v13, v13, 14, v165
    v_lshl_add_u32 v14, v14, 14, v166
    buffer_load_dwordx4 v12, s[12:15], s37 offen offset:0 nt lds
    buffer_load_dwordx4 v13, s[12:15], s37 offen offset:1024 nt lds
    buffer_load_dwordx4 v14, s[12:15], s37 offen offset:2048 nt lds
L_chk13:
    s_waitcnt lgkmcnt(0)
    v_readfirstlane_b32 s32, v162
    s_cmp_gt_u32 s32, 13
    s_cbranch_scc0 L_retry13
    ds_read_b32 v160, v5 offset:28
    ds_read_b128 v[112:115], v9 offset:49152
    ds_read_b128 v[116:119], v9 offset:50176
    ds_read_b128 v[120:123], v9 offset:51200
    ds_read_b128 v[124:127], v9 offset:52224
    ds_read_b128 v[128:131], v9 offset:53248
    ds_read_b128 v[132:135], v9 offset:54272
    s_add_u32 s36, s50, 98304
    buffer_store_dwordx4 v[136:139], v52, s[16:19], s36 offen offset:0 sc1
    buffer_store_dwordx4 v[140:143], v53, s[16:19], s36 offen offset:1024 sc1
    buffer_store_dwordx4 v[144:147], v54, s[16:19], s36 offen offset:2048 sc1
    s_mov_b32 m0, 33792
    s_add_u32 s32, s55, 0
    buffer_load_dwordx4 v82, s[8:11], s32 offen offset:0 nt lds
    buffer_load_dwordx4 v83, s[8:11], s32 offen offset:1024 nt lds
    buffer_load_dwordx4 v84, s[8:11], s32 offen offset:2048 nt lds
    s_add_u32 s36, s50, 98304
    buffer_store_dwordx4 v[148:151], v55, s[16:19], s36 offen offset:0 sc1
    buffer_store_dwordx4 v[152:155], v56, s[16:19], s36 offen offset:1024 sc1
    buffer_store_dwordx4 v[156:159], v57, s[16:19], s36 offen offset:2048 sc1
    s_mov_b32 m0, 39936
    s_add_u32 s32, s55, 98304
    buffer_load_dwordx4 v82, s[8:11], s32 offen offset:0 nt lds
    buffer_load_dwordx4 v83, s[8:11], s32 offen offset:1024 nt lds
    buffer_load_dwordx4 v84, s[8:11], s32 offen offset:2048 nt lds
L_chk14:
    s_waitcnt lgkmcnt(0)
    v_readfirstlane_b32 s32, v160
    s_cmp_gt_u32 s32, 14
    s_cbranch_scc0 L_retry14
    ds_read_b32 v162, v5 offset:28
    ds_read_b128 v[136:139], v9 offset:55296
    ds_read_b128 v[140:143], v9 offset:56320
    ds_read_b128 v[144:147], v9 offset:57344
    ds_read_b128 v[148:151], v9 offset:58368
    ds_read_b128 v[152:155], v9 offset:59392
    ds_read_b128 v[156:159], v9 offset:60416
    s_add_u32 s36, s51, 0
    buffer_store_dwordx4 v[112:115], v58, s[16:19], s36 offen offset:0 sc1
    buffer_store_dwordx4 v[116:119], v59, s[16:19], s36 offen offset:1024 sc1
    buffer_store_dwordx4 v[120:123], v60, s[16:19], s36 offen offset:2048 sc1
    s_waitcnt vmcnt(51)
    v_mov_b32 v6, 34
    ds_write_b32 v5, v6 offset:0
    s_add_u32 s36, s51, 0
    buffer_store_dwordx4 v[124:127], v61, s[16:19], s36 offen offset:0 sc1
    buffer_store_dwordx4 v[128:131], v62, s[16:19], s36 offen offset:1024 sc1
    buffer_store_dwordx4 v[132:135], v63, s[16:19], s36 offen offset:2048 sc1
    s_mov_b32 m0, 36864
    s_add_u32 s32, s55, 0
    buffer_load_dwordx4 v85, s[8:11], s32 offen offset:0 nt lds
    buffer_load_dwordx4 v86, s[8:11], s32 offen offset:1024 nt lds
    buffer_load_dwordx4 v87, s[8:11], s32 offen offset:2048 nt lds
    s_waitcnt vmcnt(36)
    v_mov_b32 v6, 35
    ds_write_b32 v5, v6 offset:0
L_chk15:
    s_waitcnt lgkmcnt(0)
    v_readfirstlane_b32 s32, v162
    s_cmp_gt_u32 s32, 15
    s_cbranch_scc0 L_retry15
    ds_read_b32 v160, v5 offset:16
    ds_read_b128 v[112:115], v11 offset:3072
    ds_read_b128 v[116:119], v11 offset:4096
    ds_read_b128 v[120:123], v11 offset:5120
    ds_read_b128 v[124:127], v11 offset:6144
    ds_read_b128 v[128:131], v11 offset:7168
    ds_read_b128 v[132:135], v11 offset:8192
    s_add_u32 s36, s51, 98304
    buffer_store_dwordx4 v[136:139], v58, s[16:19], s36 offen offset:0 sc1
    buffer_store_dwordx4 v[140:143], v59, s[16:19], s36 offen offset:1024 sc1
    buffer_store_dwordx4 v[144:147], v60, s[16:19], s36 offen offset:2048 sc1
    s_mov_b32 m0, 43008
    s_add_u32 s32, s55, 98304
    buffer_load_dwordx4 v85, s[8:11], s32 offen offset:0 nt lds
    buffer_load_dwordx4 v86, s[8:11], s32 offen offset:1024 nt lds
    buffer_load_dwordx4 v87, s[8:11], s32 offen offset:2048 nt lds
    s_waitcnt vmcnt(36)
    v_mov_b32 v6, 36
    ds_write_b32 v5, v6 offset:0
    s_add_u32 s36, s51, 98304
    buffer_store_dwordx4 v[148:151], v61, s[16:19], s36 offen offset:0 sc1
    buffer_store_dwordx4 v[152:155], v62, s[16:19], s36 offen offset:1024 sc1
    buffer_store_dwordx4 v[156:159], v63, s[16:19], s36 offen offset:2048 sc1
    s_xor_b32 s32, s7, 8
    s_lshl_b32 s33, s32, 1
    s_sub_u32 s33, 34, s33
    s_lshr_b64 s[62:63], s[60:61], s33
    s_lshl_b32 s32, s32, 10
    s_add_u32 s37, s29, s32
    s_lshl_b32 s32, s32, 1
    s_add_u32 s56, s28, s32
    v_bfe_u32 v88, s62, 0, 2
    v_bfe_u32 v89, s62, 0, 2
    v_bfe_u32 v90, s62, v170, 2
    v_lshl_add_u32 v88, v88, 15, v1
    v_lshl_add_u32 v89, v89, 15, v2
    v_lshl_add_u32 v90, v90, 15, v3
    v_bfe_u32 v91, s62, 2, 2
    v_bfe_u32 v92, s62, v171, 2
    v_bfe_u32 v93, s62, 4, 2
    v_lshl_add_u32 v91, v91, 15, v174
    v_lshl_add_u32 v92, v92, 15, v175
    v_lshl_add_u32 v93, v93, 15, v176
    v_bfe_u32 v12, s62, 0, 2
    v_bfe_u32 v13, s62, v167, 2
    v_bfe_u32 v14, s62, v168, 2
    s_mov_b32 m0, 46080
    v_lshl_add_u32 v12, v12, 14, v164
    v_lshl_add_u32 v13, v13, 14, v165
    v_lshl_add_u32 v14, v14, 14, v166
    buffer_load_dwordx4 v12, s[12:15], s37 offen offset:0 nt lds
    buffer_load_dwordx4 v13, s[12:15], s37 offen offset:1024 nt lds
    buffer_load_dwordx4 v14, s[12:15], s37 offen offset:2048 nt lds
L_chk16:
    s_waitcnt lgkmcnt(0)
    v_readfirstlane_b32 s32, v160
    s_cmp_gt_u32 s32, 16
    s_cbranch_scc0 L_retry16
    ds_read_b32 v162, v5 offset:16
    ds_read_b128 v[136:139], v11 offset:9216
    ds_read_b128 v[140:143], v11 offset:10240
    ds_read_b128 v[144:147], v11 offset:11264
    ds_read_b128 v[148:151], v11 offset:12288
    ds_read_b128 v[152:155], v11 offset:13312
    ds_read_b128 v[156:159], v11 offset:14336
    s_add_u32 s36, s52, 0
    buffer_store_dwordx4 v[112:115], v64, s[16:19], s36 offen offset:0 sc1
    buffer_store_dwordx4 v[116:119], v65, s[16:19], s36 offen offset:1024 sc1
    buffer_store_dwordx4 v[120:123], v66, s[16:19], s36 offen offset:2048 sc1
    s_waitcnt vmcnt(36)
    v_mov_b32 v6, 37
    ds_write_b32 v5, v6 offset:0
    s_add_u32 s36, s52, 0
    buffer_store_dwordx4 v[124:127], v67, s[16:19], s36 offen offset:0 sc1
    buffer_store_dwordx4 v[128:131], v68, s[16:19], s36 offen offset:1024 sc1
    buffer_store_dwordx4 v[132:135], v69, s[16:19], s36 offen offset:2048 sc1
    s_mov_b32 m0, 49152
    s_add_u32 s32, s56, 0
    buffer_load_dwordx4 v88, s[8:11], s32 offen offset:0 nt lds
    buffer_load_dwordx4 v89, s[8:11], s32 offen offset:1024 nt lds
    buffer_load_dwordx4 v90, s[8:11], s32 offen offset:2048 nt lds
L_chk17:
    s_waitcnt lgkmcnt(0)
    v_readfirstlane_b32 s32, v162
    s_cmp_gt_u32 s32, 17
    s_cbranch_scc0 L_retry17
    ds_read_b32 v160, v5 offset:20
    ds_read_b128 v[112:115], v4 offset:3072
    ds_read_b128 v[116:119], v4 offset:4096
    ds_read_b128 v[120:123], v4 offset:5120
    ds_read_b128 v[124:127], v4 offset:6144
    ds_read_b128 v[128:131], v4 offset:7168
    ds_read_b128 v[132:135], v4 offset:8192
    s_add_u32 s36, s52, 98304
    buffer_store_dwordx4 v[136:139], v64, s[16:19], s36 offen offset:0 sc1
    buffer_store_dwordx4 v[140:143], v65, s[16:19], s36 offen offset:1024 sc1
    buffer_store_dwordx4 v[144:147], v66, s[16:19], s36 offen offset:2048 sc1
    s_mov_b32 m0, 55296
    s_add_u32 s32, s56, 98304
    buffer_load_dwordx4 v88, s[8:11], s32 offen offset:0 nt lds
    buffer_load_dwordx4 v89, s[8:11], s32 offen offset:1024 nt lds
    buffer_load_dwordx4 v90, s[8:11], s32 offen offset:2048 nt lds
    s_add_u32 s36, s52, 98304
    buffer_store_dwordx4 v[148:151], v67, s[16:19], s36 offen offset:0 sc1
    buffer_store_dwordx4 v[152:155], v68, s[16:19], s36 offen offset:1024 sc1
    buffer_store_dwordx4 v[156:159], v69, s[16:19], s36 offen offset:2048 sc1
    s_mov_b32 m0, 52224
    s_add_u32 s32, s56, 0
    buffer_load_dwordx4 v91, s[8:11], s32 offen offset:0 nt lds
    buffer_load_dwordx4 v92, s[8:11], s32 offen offset:1024 nt lds
    buffer_load_dwordx4 v93, s[8:11], s32 offen offset:2048 nt lds
L_chk18:
    s_waitcnt lgkmcnt(0)
    v_readfirstlane_b32 s32, v160
    s_cmp_gt_u32 s32, 18
    s_cbranch_scc0 L_retry18
    ds_read_b32 v162, v5 offset:20
    ds_read_b128 v[136:139], v4 offset:9216
    ds_read_b128 v[140:143], v4 offset:10240
    ds_read_b128 v[144:147], v4 offset:11264
    ds_read_b128 v[148:151], v4 offset:12288
    ds_read_b128 v[152:155], v4 offset:13312
    ds_read_b128 v[156:159], v4 offset:14336
    s_add_u32 s36, s53, 0
    buffer_store_dwordx4 v[112:115], v70, s[16:19], s36 offen offset:0 sc1
    buffer_store_dwordx4 v[116:119], v71, s[16:19], s36 offen offset:1024 sc1
    buffer_store_dwordx4 v[120:123], v72, s[16:19], s36 offen offset:2048 sc1
    s_waitcnt vmcnt(36)
    v_mov_b32 v6, 38
    ds_write_b32 v5, v6 offset:0
    s_add_u32 s36, s53, 0
    buffer_store_dwordx4 v[124:127], v73, s[16:19], s36 offen offset:0 sc1
    buffer_store_dwordx4 v[128:131], v74, s[16:19], s36 offen offset:1024 sc1
    buffer_store_dwordx4 v[132:135], v75, s[16:19], s36 offen offset:2048 sc1
    s_mov_b32 m0, 58368
    s_add_u32 s32, s56, 98304
    buffer_load_dwordx4 v91, s[8:11], s32 offen offset:0 nt lds
    buffer_load_dwordx4 v92, s[8:11], s32 offen offset:1024 nt lds
    buffer_load_dwordx4 v93, s[8:11], s32 offen offset:2048 nt lds
    s_waitcnt vmcnt(36)
    v_mov_b32 v6, 39
    ds_write_b32 v5, v6 offset:0
L_chk19:
    s_waitcnt lgkmcnt(0)
    v_readfirstlane_b32 s32, v162
    s_cmp_gt_u32 s32, 19
    s_cbranch_scc0 L_retry19
    ds_read_b32 v160, v5 offset:24
    ds_read_b128 v[112:115], v4 offset:18432
    ds_read_b128 v[116:119], v4 offset:19456
    ds_read_b128 v[120:123], v4 offset:20480
    ds_read_b128 v[124:127], v4 offset:21504
    ds_read_b128 v[128:131], v4 offset:22528
    ds_read_b128 v[132:135], v4 offset:23552
    s_add_u32 s36, s53, 98304
    buffer_store_dwordx4 v[136:139], v70, s[16:19], s36 offen offset:0 sc1
    buffer_store_dwordx4 v[140:143], v71, s[16:19], s36 offen offset:1024 sc1
    buffer_store_dwordx4 v[144:147], v72, s[16:19], s36 offen offset:2048 sc1
    s_xor_b32 s32, s7, 9
    s_lshl_b32 s33, s32, 1
    s_sub_u32 s33, 34, s33
    s_lshr_b64 s[62:63], s[60:61], s33
    s_lshl_b32 s32, s32, 10
    s_add_u32 s37, s29, s32
    s_lshl_b32 s32, s32, 1
    s_add_u32 s57, s28, s32
    v_bfe_u32 v94, s62, 0, 2
    v_bfe_u32 v95, s62, 0, 2
    v_bfe_u32 v96, s62, v170, 2
    v_lshl_add_u32 v94, v94, 15, v1
    v_lshl_add_u32 v95, v95, 15, v2
    v_lshl_add_u32 v96, v96, 15, v3
    v_bfe_u32 v97, s62, 2, 2
    v_bfe_u32 v98, s62, v171, 2
    v_bfe_u32 v99, s62, 4, 2
    v_lshl_add_u32 v97, v97, 15, v174
    v_lshl_add_u32 v98, v98, 15, v175
    v_lshl_add_u32 v99, v99, 15, v176
    v_bfe_u32 v12, s62, 0, 2
    v_bfe_u32 v13, s62, v167, 2
    v_bfe_u32 v14, s62, v168, 2
    s_mov_b32 m0, 61440
    v_lshl_add_u32 v12, v12, 14, v164
    v_lshl_add_u32 v13, v13, 14, v165
    v_lshl_add_u32 v14, v14, 14, v166
    buffer_load_dwordx4 v12, s[12:15], s37 offen offset:0 nt lds
    buffer_load_dwordx4 v13, s[12:15], s37 offen offset:1024 nt lds
    buffer_load_dwordx4 v14, s[12:15], s37 offen offset:2048 nt lds
    s_waitcnt vmcnt(36)
    v_mov_b32 v6, 40
    ds_write_b32 v5, v6 offset:0
    s_add_u32 s36, s53, 98304
    buffer_store_dwordx4 v[148:151], v73, s[16:19], s36 offen offset:0 sc1
    buffer_store_dwordx4 v[152:155], v74, s[16:19], s36 offen offset:1024 sc1
    buffer_store_dwordx4 v[156:159], v75, s[16:19], s36 offen offset:2048 sc1
    s_mov_b32 m0, 64512
    s_add_u32 s32, s57, 0
    buffer_load_dwordx4 v94, s[8:11], s32 offen offset:0 nt lds
    buffer_load_dwordx4 v95, s[8:11], s32 offen offset:1024 nt lds
    buffer_load_dwordx4 v96, s[8:11], s32 offen offset:2048 nt lds
L_chk20:
    s_waitcnt lgkmcnt(0)
    v_readfirstlane_b32 s32, v160
    s_cmp_gt_u32 s32, 20
    s_cbranch_scc0 L_retry20
    ds_read_b32 v162, v5 offset:24
    ds_read_b128 v[136:139], v4 offset:24576
    ds_read_b128 v[140:143], v4 offset:25600
    ds_read_b128 v[144:147], v4 offset:26624
    ds_read_b128 v[148:151], v4 offset:27648
    ds_read_b128 v[152:155], v4 offset:28672
    ds_read_b128 v[156:159], v4 offset:29696
    s_add_u32 s36, s54, 0
    buffer_store_dwordx4 v[112:115], v76, s[16:19], s36 offen offset:0 sc1
    buffer_store_dwordx4 v[116:119], v77, s[16:19], s36 offen offset:1024 sc1
    buffer_store_dwordx4 v[120:123], v78, s[16:19], s36 offen offset:2048 sc1
    s_add_u32 s36, s54, 0
    buffer_store_dwordx4 v[124:127], v79, s[16:19], s36 offen offset:0 sc1
    buffer_store_dwordx4 v[128:131], v80, s[16:19], s36 offen offset:1024 sc1
    buffer_store_dwordx4 v[132:135], v81, s[16:19], s36 offen offset:2048 sc1
    s_mov_b32 m0, 70656
    s_add_u32 s32, s57, 98304
    buffer_load_dwordx4 v94, s[8:11], s32 offen offset:0 nt lds
    buffer_load_dwordx4 v95, s[8:11], s32 offen offset:1024 nt lds
    buffer_load_dwordx4 v96, s[8:11], s32 offen offset:2048 nt lds
L_chk21:
    s_waitcnt lgkmcnt(0)
    v_readfirstlane_b32 s32, v162
    s_cmp_gt_u32 s32, 21
    s_cbranch_scc0 L_retry21
    ds_read_b32 v160, v5 offset:28
    ds_read_b128 v[112:115], v4 offset:33792
    ds_read_b128 v[116:119], v4 offset:34816
    ds_read_b128 v[120:123], v4 offset:35840
    ds_read_b128 v[124:127], v4 offset:36864
    ds_read_b128 v[128:131], v4 offset:37888
    ds_read_b128 v[132:135], v4 offset:38912
    s_add_u32 s36, s54, 98304
    buffer_store_dwordx4 v[136:139], v76, s[16:19], s36 offen offset:0 sc1
    buffer_store_dwordx4 v[140:143], v77, s[16:19], s36 offen offset:1024 sc1
    buffer_store_dwordx4 v[144:147], v78, s[16:19], s36 offen offset:2048 sc1
    s_mov_b32 m0, 67584
    s_add_u32 s32, s57, 0
    buffer_load_dwordx4 v97, s[8:11], s32 offen offset:0 nt lds
    buffer_load_dwordx4 v98, s[8:11], s32 offen offset:1024 nt lds
    buffer_load_dwordx4 v99, s[8:11], s32 offen offset:2048 nt lds
    s_waitcnt vmcnt(36)
    v_mov_b32 v6, 41
    ds_write_b32 v5, v6 offset:0
    s_add_u32 s36, s54, 98304
    buffer_store_dwordx4 v[148:151], v79, s[16:19], s36 offen offset:0 sc1
    buffer_store_dwordx4 v[152:155], v80, s[16:19], s36 offen offset:1024 sc1
    buffer_store_dwordx4 v[156:159], v81, s[16:19], s36 offen offset:2048 sc1
    s_mov_b32 m0, 73728
    s_add_u32 s32, s57, 98304
    buffer_load_dwordx4 v97, s[8:11], s32 offen offset:0 nt lds
    buffer_load_dwordx4 v98, s[8:11], s32 offen offset:1024 nt lds
    buffer_load_dwordx4 v99, s[8:11], s32 offen offset:2048 nt lds
    s_branch L_chk22
L_retry22:
    ds_read_b32 v160, v5 offset:28
    ds_read_b128 v[112:115], v4 offset:33792
    ds_read_b128 v[116:119], v4 offset:34816
    ds_read_b128 v[120:123], v4 offset:35840
    ds_read_b128 v[124:127], v4 offset:36864
    ds_read_b128 v[128:131], v4 offset:37888
    ds_read_b128 v[132:135], v4 offset:38912
L_chk22:
    s_waitcnt lgkmcnt(0)
    v_readfirstlane_b32 s32, v160
    s_cmp_gt_u32 s32, 22
    s_cbranch_scc0 L_retry22
    ds_read_b32 v162, v5 offset:28
    ds_read_b128 v[136:139], v4 offset:39936
    ds_read_b128 v[140:143], v4 offset:40960
    ds_read_b128 v[144:147], v4 offset:41984
    ds_read_b128 v[148:151], v4 offset:43008
    ds_read_b128 v[152:155], v4 offset:44032
    ds_read_b128 v[156:159], v4 offset:45056
    s_add_u32 s36, s55, 0
    buffer_store_dwordx4 v[112:115], v82, s[16:19], s36 offen offset:0 sc1
    buffer_store_dwordx4 v[116:119], v83, s[16:19], s36 offen offset:1024 sc1
    buffer_store_dwordx4 v[120:123], v84, s[16:19], s36 offen offset:2048 sc1
    s_waitcnt vmcnt(36)
    v_mov_b32 v6, 42
    ds_write_b32 v5, v6 offset:0
    s_add_u32 s36, s55, 0
    buffer_store_dwordx4 v[124:127], v85, s[16:19], s36 offen offset:0 sc1
    buffer_store_dwordx4 v[128:131], v86, s[16:19], s36 offen offset:1024 sc1
    buffer_store_dwordx4 v[132:135], v87, s[16:19], s36 offen offset:2048 sc1
    s_xor_b32 s32, s7, 10
    s_lshl_b32 s33, s32, 1
    s_sub_u32 s33, 34, s33
    s_lshr_b64 s[62:63], s[60:61], s33
    s_lshl_b32 s32, s32, 10
    s_add_u32 s37, s29, s32
    s_lshl_b32 s32, s32, 1
    s_add_u32 s58, s28, s32
    v_bfe_u32 v100, s62, 0, 2
    v_bfe_u32 v101, s62, 0, 2
    v_bfe_u32 v102, s62, v170, 2
    v_lshl_add_u32 v100, v100, 15, v1
    v_lshl_add_u32 v101, v101, 15, v2
    v_lshl_add_u32 v102, v102, 15, v3
    v_bfe_u32 v103, s62, 2, 2
    v_bfe_u32 v104, s62, v171, 2
    v_bfe_u32 v105, s62, 4, 2
    v_lshl_add_u32 v103, v103, 15, v174
    v_lshl_add_u32 v104, v104, 15, v175
    v_lshl_add_u32 v105, v105, 15, v176
    v_mov_b32 v172, s58
    v_mov_b32 v173, s62
    ds_write_b64 v5, v[172:173] offset:32
    v_bfe_u32 v12, s62, 0, 2
    v_bfe_u32 v13, s62, v167, 2
    v_bfe_u32 v14, s62, v168, 2
    s_mov_b32 m0, 76800
    v_lshl_add_u32 v12, v12, 14, v164
    v_lshl_add_u32 v13, v13, 14, v165
    v_lshl_add_u32 v14, v14, 14, v166
    buffer_load_dwordx4 v12, s[12:15], s37 offen offset:0 nt lds
    buffer_load_dwordx4 v13, s[12:15], s37 offen offset:1024 nt lds
    buffer_load_dwordx4 v14, s[12:15], s37 offen offset:2048 nt lds
    s_waitcnt vmcnt(36)
    v_mov_b32 v6, 43
    ds_write_b32 v5, v6 offset:0
    s_branch L_chk23
L_retry23:
    ds_read_b32 v162, v5 offset:28
    ds_read_b128 v[136:139], v4 offset:39936
    ds_read_b128 v[140:143], v4 offset:40960
    ds_read_b128 v[144:147], v4 offset:41984
    ds_read_b128 v[148:151], v4 offset:43008
    ds_read_b128 v[152:155], v4 offset:44032
    ds_read_b128 v[156:159], v4 offset:45056
L_chk23:
    s_waitcnt lgkmcnt(0)
    v_readfirstlane_b32 s32, v162
    s_cmp_gt_u32 s32, 23
    s_cbranch_scc0 L_retry23
    ds_read_b64 v[160:161], v5 offset:16
    ds_read_b128 v[112:115], v4 offset:49152
    ds_read_b128 v[116:119], v4 offset:50176
    ds_read_b128 v[120:123], v4 offset:51200
    ds_read_b128 v[124:127], v4 offset:52224
    ds_read_b128 v[128:131], v4 offset:53248
    ds_read_b128 v[132:135], v4 offset:54272
    s_add_u32 s36, s55, 98304
    buffer_store_dwordx4 v[136:139], v82, s[16:19], s36 offen offset:0 sc1
    buffer_store_dwordx4 v[140:143], v83, s[16:19], s36 offen offset:1024 sc1
    buffer_store_dwordx4 v[144:147], v84, s[16:19], s36 offen offset:2048 sc1
    s_xor_b32 s32, s7, 11
    s_lshl_b32 s33, s32, 1
    s_sub_u32 s33, 34, s33
    s_lshr_b64 s[62:63], s[60:61], s33
    s_lshl_b32 s32, s32, 10
    s_add_u32 s37, s29, s32
    s_lshl_b32 s32, s32, 1
    s_add_u32 s59, s28, s32
    v_bfe_u32 v106, s62, 0, 2
    v_bfe_u32 v107, s62, 0, 2
    v_bfe_u32 v108, s62, v170, 2
    v_lshl_add_u32 v106, v106, 15, v1
    v_lshl_add_u32 v107, v107, 15, v2
    v_lshl_add_u32 v108, v108, 15, v3
    v_bfe_u32 v109, s62, 2, 2
    v_bfe_u32 v110, s62, v171, 2
    v_bfe_u32 v111, s62, 4, 2
    v_lshl_add_u32 v109, v109, 15, v174
    v_lshl_add_u32 v110, v110, 15, v175
    v_lshl_add_u32 v111, v111, 15, v176
    v_mov_b32 v172, s59
    v_mov_b32 v173, s62
    ds_write_b64 v5, v[172:173] offset:40
    v_bfe_u32 v12, s62, 0, 2
    v_bfe_u32 v13, s62, v167, 2
    v_bfe_u32 v14, s62, v168, 2
    s_mov_b32 m0, 92160
    v_lshl_add_u32 v12, v12, 14, v164
    v_lshl_add_u32 v13, v13, 14, v165
    v_lshl_add_u32 v14, v14, 14, v166
    buffer_load_dwordx4 v12, s[12:15], s37 offen offset:0 nt lds
    buffer_load_dwordx4 v13, s[12:15], s37 offen offset:1024 nt lds
    buffer_load_dwordx4 v14, s[12:15], s37 offen offset:2048 nt lds
    s_add_u32 s36, s55, 98304
    buffer_store_dwordx4 v[148:151], v85, s[16:19], s36 offen offset:0 sc1
    buffer_store_dwordx4 v[152:155], v86, s[16:19], s36 offen offset:1024 sc1
    buffer_store_dwordx4 v[156:159], v87, s[16:19], s36 offen offset:2048 sc1
    s_mov_b32 m0, 79872
    s_add_u32 s32, s58, 0
    buffer_load_dwordx4 v100, s[8:11], s32 offen offset:0 nt lds
    buffer_load_dwordx4 v101, s[8:11], s32 offen offset:1024 nt lds
    buffer_load_dwordx4 v102, s[8:11], s32 offen offset:2048 nt lds
    s_branch L_chk24
L_retry24:
    ds_read_b64 v[160:161], v5 offset:16
    ds_read_b128 v[112:115], v4 offset:49152
    ds_read_b128 v[116:119], v4 offset:50176
    ds_read_b128 v[120:123], v4 offset:51200
    ds_read_b128 v[124:127], v4 offset:52224
    ds_read_b128 v[128:131], v4 offset:53248
    ds_read_b128 v[132:135], v4 offset:54272
L_chk24:
    s_waitcnt lgkmcnt(0)
    v_min_u32 v160, v160, v161
    s_nop 0
    v_readfirstlane_b32 s32, v160
    s_cmp_gt_u32 s32, 25
    s_cbranch_scc0 L_retry24
    ds_read_b64 v[162:163], v5 offset:24
    ds_read_b128 v[136:139], v4 offset:55296
    ds_read_b128 v[140:143], v4 offset:56320
    ds_read_b128 v[144:147], v4 offset:57344
    ds_read_b128 v[148:151], v4 offset:58368
    ds_read_b128 v[152:155], v4 offset:59392
    ds_read_b128 v[156:159], v4 offset:60416
    s_add_u32 s36, s56, 0
    buffer_store_dwordx4 v[112:115], v88, s[16:19], s36 offen offset:0 sc1
    buffer_store_dwordx4 v[116:119], v89, s[16:19], s36 offen offset:1024 sc1
    buffer_store_dwordx4 v[120:123], v90, s[16:19], s36 offen offset:2048 sc1
    s_add_u32 s36, s56, 0
    buffer_store_dwordx4 v[124:127], v91, s[16:19], s36 offen offset:0 sc1
    buffer_store_dwordx4 v[128:131], v92, s[16:19], s36 offen offset:1024 sc1
    buffer_store_dwordx4 v[132:135], v93, s[16:19], s36 offen offset:2048 sc1
    s_mov_b32 m0, 86016
    s_add_u32 s32, s58, 98304
    buffer_load_dwordx4 v100, s[8:11], s32 offen offset:0 nt lds
    buffer_load_dwordx4 v101, s[8:11], s32 offen offset:1024 nt lds
    buffer_load_dwordx4 v102, s[8:11], s32 offen offset:2048 nt lds
    s_waitcnt vmcnt(36)
    v_mov_b32 v6, 44
    ds_write_b32 v5, v6 offset:0
    s_branch L_chk25
L_retry25:
    ds_read_b64 v[162:163], v5 offset:24
    ds_read_b128 v[136:139], v4 offset:55296
    ds_read_b128 v[140:143], v4 offset:56320
    ds_read_b128 v[144:147], v4 offset:57344
    ds_read_b128 v[148:151], v4 offset:58368
    ds_read_b128 v[152:155], v4 offset:59392
    ds_read_b128 v[156:159], v4 offset:60416
L_chk25:
    s_waitcnt lgkmcnt(0)
    v_min_u32 v162, v162, v163
    s_nop 0
    v_readfirstlane_b32 s32, v162
    s_cmp_gt_u32 s32, 25
    s_cbranch_scc0 L_retry25
    ds_read_b64 v[160:161], v5 offset:16
    ds_read_b128 v[112:115], v9 offset:3072
    ds_read_b128 v[116:119], v9 offset:4096
    ds_read_b128 v[120:123], v9 offset:5120
    ds_read_b128 v[124:127], v9 offset:6144
    ds_read_b128 v[128:131], v9 offset:7168
    ds_read_b128 v[132:135], v9 offset:8192
    s_add_u32 s36, s56, 98304
    buffer_store_dwordx4 v[136:139], v88, s[16:19], s36 offen offset:0 sc1
    buffer_store_dwordx4 v[140:143], v89, s[16:19], s36 offen offset:1024 sc1
    buffer_store_dwordx4 v[144:147], v90, s[16:19], s36 offen offset:2048 sc1
    s_mov_b32 m0, 82944
    s_add_u32 s32, s58, 0
    buffer_load_dwordx4 v103, s[8:11], s32 offen offset:0 nt lds
    buffer_load_dwordx4 v104, s[8:11], s32 offen offset:1024 nt lds
    buffer_load_dwordx4 v105, s[8:11], s32 offen offset:2048 nt lds
    s_waitcnt vmcnt(36)
    v_mov_b32 v6, 45
    ds_write_b32 v5, v6 offset:0
    s_add_u32 s36, s56, 98304
    buffer_store_dwordx4 v[148:151], v91, s[16:19], s36 offen offset:0 sc1
    buffer_store_dwordx4 v[152:155], v92, s[16:19], s36 offen offset:1024 sc1
    buffer_store_dwordx4 v[156:159], v93, s[16:19], s36 offen offset:2048 sc1
    s_mov_b32 m0, 89088
    s_add_u32 s32, s58, 98304
    buffer_load_dwordx4 v103, s[8:11], s32 offen offset:0 nt lds
    buffer_load_dwordx4 v104, s[8:11], s32 offen offset:1024 nt lds
    buffer_load_dwordx4 v105, s[8:11], s32 offen offset:2048 nt lds
    s_branch L_chk26
L_retry26:
    ds_read_b64 v[160:161], v5 offset:16
    ds_read_b128 v[112:115], v9 offset:3072
    ds_read_b128 v[116:119], v9 offset:4096
    ds_read_b128 v[120:123], v9 offset:5120
    ds_read_b128 v[124:127], v9 offset:6144
    ds_read_b128 v[128:131], v9 offset:7168
    ds_read_b128 v[132:135], v9 offset:8192
L_chk26:
    s_waitcnt lgkmcnt(0)
    v_min_u32 v160, v160, v161
    s_nop 0
    v_readfirstlane_b32 s32, v160
    s_cmp_gt_u32 s32, 27
    s_cbranch_scc0 L_retry26
    ds_read_b64 v[162:163], v5 offset:24
    ds_read_b128 v[136:139], v9 offset:9216
    ds_read_b128 v[140:143], v9 offset:10240
    ds_read_b128 v[144:147], v9 offset:11264
    ds_read_b128 v[148:151], v9 offset:12288
    ds_read_b128 v[152:155], v9 offset:13312
    ds_read_b128 v[156:159], v9 offset:14336
    s_add_u32 s36, s57, 0
    buffer_store_dwordx4 v[112:115], v94, s[16:19], s36 offen offset:0 sc1
    buffer_store_dwordx4 v[116:119], v95, s[16:19], s36 offen offset:1024 sc1
    buffer_store_dwordx4 v[120:123], v96, s[16:19], s36 offen offset:2048 sc1
    s_add_u32 s36, s57, 0
    buffer_store_dwordx4 v[124:127], v97, s[16:19], s36 offen offset:0 sc1
    buffer_store_dwordx4 v[128:131], v98, s[16:19], s36 offen offset:1024 sc1
    buffer_store_dwordx4 v[132:135], v99, s[16:19], s36 offen offset:2048 sc1
    s_mov_b32 m0, 95232
    s_add_u32 s32, s59, 0
    buffer_load_dwordx4 v106, s[8:11], s32 offen offset:0 nt lds
    buffer_load_dwordx4 v107, s[8:11], s32 offen offset:1024 nt lds
    buffer_load_dwordx4 v108, s[8:11], s32 offen offset:2048 nt lds
    s_waitcnt vmcnt(36)
    v_mov_b32 v6, 46
    ds_write_b32 v5, v6 offset:0
    s_branch L_chk27
L_retry27:
    ds_read_b64 v[162:163], v5 offset:24
    ds_read_b128 v[136:139], v9 offset:9216
    ds_read_b128 v[140:143], v9 offset:10240
    ds_read_b128 v[144:147], v9 offset:11264
    ds_read_b128 v[148:151], v9 offset:12288
    ds_read_b128 v[152:155], v9 offset:13312
    ds_read_b128 v[156:159], v9 offset:14336
L_chk27:
    s_waitcnt lgkmcnt(0)
    v_min_u32 v162, v162, v163
    s_nop 0
    v_readfirstlane_b32 s32, v162
    s_cmp_gt_u32 s32, 27
    s_cbranch_scc0 L_retry27
    s_add_u32 s36, s57, 98304
    buffer_store_dwordx4 v[136:139], v94, s[16:19], s36 offen offset:0 sc1
    buffer_store_dwordx4 v[140:143], v95, s[16:19], s36 offen offset:1024 sc1
    buffer_store_dwordx4 v[144:147], v96, s[16:19], s36 offen offset:2048 sc1
    s_mov_b32 m0, 101376
    s_add_u32 s32, s59, 98304
    buffer_load_dwordx4 v106, s[8:11], s32 offen offset:0 nt lds
    buffer_load_dwordx4 v107, s[8:11], s32 offen offset:1024 nt lds
    buffer_load_dwordx4 v108, s[8:11], s32 offen offset:2048 nt lds
    s_waitcnt vmcnt(36)
    v_mov_b32 v6, 47
    ds_write_b32 v5, v6 offset:0
    s_add_u32 s36, s57, 98304
    buffer_store_dwordx4 v[148:151], v97, s[16:19], s36 offen offset:0 sc1
    buffer_store_dwordx4 v[152:155], v98, s[16:19], s36 offen offset:1024 sc1
    buffer_store_dwordx4 v[156:159], v99, s[16:19], s36 offen offset:2048 sc1
    s_mov_b32 m0, 98304
    s_add_u32 s32, s59, 0
    buffer_load_dwordx4 v109, s[8:11], s32 offen offset:0 nt lds
    buffer_load_dwordx4 v110, s[8:11], s32 offen offset:1024 nt lds
    buffer_load_dwordx4 v111, s[8:11], s32 offen offset:2048 nt lds
    s_mov_b32 m0, 104448
    s_add_u32 s32, s59, 98304
    buffer_load_dwordx4 v109, s[8:11], s32 offen offset:0 nt lds
    buffer_load_dwordx4 v110, s[8:11], s32 offen offset:1024 nt lds
    buffer_load_dwordx4 v111, s[8:11], s32 offen offset:2048 nt lds
    s_waitcnt vmcnt(36)
    v_mov_b32 v6, 48
    ds_write_b32 v5, v6 offset:0
    s_waitcnt vmcnt(30)
    v_mov_b32 v6, 49
    ds_write_b32 v5, v6 offset:0
    s_waitcnt vmcnt(24)
    v_mov_b32 v6, 50
    ds_write_b32 v5, v6 offset:0
    s_waitcnt vmcnt(15)
    v_mov_b32 v6, 51
    ds_write_b32 v5, v6 offset:0
    s_waitcnt vmcnt(9)
    v_mov_b32 v6, 52
    ds_write_b32 v5, v6 offset:0
    s_waitcnt vmcnt(3)
    v_mov_b32 v6, 53
    ds_write_b32 v5, v6 offset:0
    s_waitcnt vmcnt(0)
    v_mov_b32 v6, 54
    ds_write_b32 v5, v6 offset:0
    s_branch L_fin
L_help:
    s_mul_i32 s32, s42, 12
    s_add_u32 s32, s32, 9
    s_lshr_b32 s32, s32, 6
    s_and_b32 s33, s32, 1
    s_lshl_b32 s33, s33, 7
    s_lshr_b32 s32, s32, 1
    s_lshl3_add_u32 s44, s32, s33
    s_and_b32 s32, s42, 15
    s_mul_i32 s33, s32, 52
    s_lshr_b32 s33, s33, 8
    s_min_u32 s33, s33, 2
    s_mul_i32 s33, s33, 5
    s_sub_u32 s32, s32, s33
    s_xor_b32 s33, s32, s6
    s_and_b32 s33, s33, 1
    s_mul_i32 s33, s33, 5
    s_add_u32 s33, s33, s32
    s_cmp_eq_u32 s32, 5
    s_cselect_b32 s33, 15, s33
    s_and_b32 s28, s32, 3
    s_mov_b32 s29, 0
    s_cmp_ge_u32 s33, 5
    s_cbranch_scc1 L_voted
    s_getreg_b32 s34, hwreg(HW_REG_XCC_ID, 2, 1)
    s_xor_b32 s35, s34, s6
    s_lshl_b32 s35, s35, 4
    s_or_b32 s35, s35, 1
    s_add_u32 s32, s28, 8
    s_lshl_b32 s35, s35, s32
    s_cmp_lt_u32 s33, 4
    s_cselect_b32 s35, s35, 0
    s_lshr_b32 s32, s43, 21
    s_xor_b32 s32, s32, s34
    s_lshr_b32 s34, s43, 13
    s_xor_b32 s32, s32, s34
    s_waitcnt lgkmcnt(0)
    s_sub_u32 s38, s38, s40
    s_cmp_lt_u32 s38, 64
    s_cselect_b32 s33, 1, 0
    s_xor_b32 s32, s32, s33
    s_bitcmp1_b32 s32, 0
    s_cselect_b32 s30, 16, 1
    s_or_b32 s30, s30, s35
    s_atomic_add s30, s[18:19], s44
L_voted:
    s_barrier
L_vw:
    s_sleep 4
    ds_read_b32 v6, v5 offset:0
    s_waitcnt lgkmcnt(0)
    v_readfirstlane_b32 s32, v6
    s_cmp_ge_u32 s32, 2
    s_cbranch_scc0 L_vw
    s_load_dword s30, s[18:19], s44
    s_waitcnt lgkmcnt(0)
L_vchk:
    s_lshr_b32 s34, s30, 24
    s_cbranch_scc1 L_vdone
    s_and_b32 s32, s30, 15
    s_bfe_u32 s33, s30, 0x40004
    s_cmp_gt_u32 s33, s32
    s_cselect_b32 s34, 15, 0
    s_bfe_u32 s35, s30, 0x4000c
    s_xor_b32 s34, s34, s35
    s_max_u32 s32, s32, s33
    s_add_u32 s33, s28, 8
    s_bitcmp1_b32 s30, s33
    s_cselect_b32 s32, s32, 0
    s_cmp_ge_u32 s32, 3
    s_cbranch_scc1 L_vdone
    s_add_u32 s29, s29, 1
    s_cmp_gt_u32 s29, 6
    s_cbranch_scc1 L_vforce
    s_mov_b32 s30, 0
    s_atomic_add s30, s[18:19], s44 glc
    s_waitcnt lgkmcnt(0)
    s_branch L_vchk
L_vforce:
    s_mov_b32 s31, s30
    s_mov_b32 s35, s30
    s_or_b32 s30, s34, 0x80
    s_lshl_b32 s30, s30, 24
    s_atomic_cmpswap s[30:31], s[18:19], s44 glc
    s_waitcnt lgkmcnt(0)
    s_cmp_lg_u32 s30, s35
    s_cbranch_scc1 L_vchk
L_vdone:
    s_lshr_b32 s34, s34, s28
    s_and_b32 s34, s34, 1
    s_or_b32 s34, s34, 2
    v_mov_b32 v6, s34
    ds_write_b32 v5, v6 offset:12
    s_branch L_fin
L_compute:
    s_sub_u32 s28, s3, 2
    v_and_b32 v7, 15, v0
    v_lshrrev_b32 v8, 4, v0
    v_mul_u32_u24 v4, 192, v7
    v_lshl_add_u32 v4, v8, 4, v4
    v_and_b32 v9, 7, v0
    v_xor_b32 v9, v9, v8
    v_lshlrev_b32 v9, 4, v9
    v_mul_u32_u24 v7, 384, v7
    v_add_u32 v7, v7, v9
    s_mul_i32 s32, s28, 15360
    v_add_u32 v13, s32, v7
    v_xor_b32 v14, 64, v13
    v_add_u32 v15, s32, v4
    v_add_u32 v4, 46080, v4
    s_lshr_b32 s32, s28, 1
    s_mul_i32 s33, s32, 6144
    s_add_u32 s33, s33, 49152
    s_add_u32 s6, s32, 1
    s_and_b32 s32, s28, 1
    s_lshl_b32 s34, s32, 6
    s_lshl_b32 s35, s32, 7
    v_xor_b32 v7, s34, v7
    s_add_u32 s33, s33, s35
    v_add_u32 v1, s33, v7
    v_add_u32 v3, 128, v1
    v_xor_b32 v7, 64, v7
    s_add_u32 s33, s33, s35
    v_add_u32 v2, s33, v7
    s_lshl_b32 s32, s28, 2
    v_add_u32 v10, s32, v5
    v_bfe_u32 v7, v0, 2, 2
    v_lshl_add_u32 v9, v8, 3, v7
    v_mul_u32_u24 v9, 192, v9
    v_and_b32 v11, 3, v0
    v_lshl_add_u32 v9, v11, 4, v9
    v_add_u32 v9, 122880, v9
    v_lshl_add_u32 v7, v7, 3, v11
    v_mul_u32_u24 v7, 192, v7
    v_lshl_add_u32 v7, v8, 4, v7
    s_mul_i32 s32, s28, 6144
    s_add_u32 s32, s32, 141312
    v_add_u32 v7, s32, v7
    v_lshlrev_b32 v11, 4, v0
    v_add_u32 v8, s32, v11
    v_add_u32 v11, 141312, v11
    v_lshlrev_b32 v12, 2, v0
    v_and_b32 v12, 63, v12
    v_add_u32 v12, v5, v12
    v_mov_b32 v6, 0
    ds_write_b32 v12, v6
    v_mov_b32 v12, 1
    s_mul_i32 s31, s28, 3
    s_add_u32 s31, s31, 4
    s_lshl_b32 s30, s28, 1
    s_mov_b32 s33, 61440
    s_cmp_eq_u32 s28, 0
    s_cselect_b32 s34, s33, 4294890496
    s_waitcnt lgkmcnt(0)
    s_barrier
L_pw0:
    ds_read_b32 v6, v5 offset:0
    s_waitcnt lgkmcnt(0)
    v_readfirstlane_b32 s29, v6
    s_cmp_ge_u32 s29, 1
    s_cbranch_scc1 L_pw0_ok
    s_sleep 1
    s_branch L_pw0
L_pw0_ok:
    ds_read_b64_tr_b16 v[88:89], v9 offset:0
    ds_read_b64_tr_b16 v[90:91], v9 offset:768
    ds_read_b64_tr_b16 v[100:101], v9 offset:8
    ds_read_b64_tr_b16 v[102:103], v9 offset:776
    ds_read_b64_tr_b16 v[112:113], v9 offset:64
    ds_read_b64_tr_b16 v[114:115], v9 offset:832
    ds_read_b64_tr_b16 v[124:125], v9 offset:72
    ds_read_b64_tr_b16 v[126:127], v9 offset:840
    ds_read_b64_tr_b16 v[136:137], v9 offset:128
    ds_read_b64_tr_b16 v[138:139], v9 offset:896
    ds_read_b64_tr_b16 v[148:149], v9 offset:136
    ds_read_b64_tr_b16 v[150:151], v9 offset:904
    s_cmp_eq_u32 s28, 3
    s_cbranch_scc1 L_pw1
    ds_read_b128 v[208:211], v7 offset:0
    ds_read_b128 v[220:223], v7 offset:768
    ds_read_b128 v[212:215], v7 offset:64
    ds_read_b128 v[224:227], v7 offset:832
    ds_read_b128 v[216:219], v7 offset:128
    ds_read_b128 v[228:231], v7 offset:896
    s_waitcnt lgkmcnt(0)
    v_mfma_f32_16x16x32_bf16 v[160:163], v[208:211], v[88:91], 0
    v_mfma_f32_16x16x32_bf16 v[164:167], v[220:223], v[88:91], 0
    v_mfma_f32_16x16x32_bf16 v[168:171], v[208:211], v[100:103], 0
    v_mfma_f32_16x16x32_bf16 v[172:175], v[220:223], v[100:103], 0
    v_mfma_f32_16x16x32_bf16 v[176:179], v[208:211], v[112:115], 0
    v_mfma_f32_16x16x32_bf16 v[180:183], v[220:223], v[112:115], 0
    v_mfma_f32_16x16x32_bf16 v[184:187], v[208:211], v[124:127], 0
    v_mfma_f32_16x16x32_bf16 v[188:191], v[220:223], v[124:127], 0
    v_mfma_f32_16x16x32_bf16 v[192:195], v[208:211], v[136:139], 0
    v_mfma_f32_16x16x32_bf16 v[196:199], v[220:223], v[136:139], 0
    v_mfma_f32_16x16x32_bf16 v[200:203], v[208:211], v[148:151], 0
    v_mfma_f32_16x16x32_bf16 v[204:207], v[220:223], v[148:151], 0
L_pw1:
    ds_read_b32 v6, v5 offset:0
    s_waitcnt lgkmcnt(0)
    v_readfirstlane_b32 s29, v6
    s_cmp_ge_u32 s29, 2
    s_cbranch_scc1 L_pw1_ok
    s_sleep 1
    s_branch L_pw1
L_pw1_ok:
    ds_read_b64_tr_b16 v[92:93], v9 offset:6144
    ds_read_b64_tr_b16 v[94:95], v9 offset:6912
    ds_read_b64_tr_b16 v[104:105], v9 offset:6152
    ds_read_b64_tr_b16 v[106:107], v9 offset:6920
    ds_read_b64_tr_b16 v[116:117], v9 offset:6208
    ds_read_b64_tr_b16 v[118:119], v9 offset:6976
    ds_read_b64_tr_b16 v[128:129], v9 offset:6216
    ds_read_b64_tr_b16 v[130:131], v9 offset:6984
    ds_read_b64_tr_b16 v[140:141], v9 offset:6272
    ds_read_b64_tr_b16 v[142:143], v9 offset:7040
    ds_read_b64_tr_b16 v[152:153], v9 offset:6280
    ds_read_b64_tr_b16 v[154:155], v9 offset:7048
    s_cmp_eq_u32 s28, 3
    s_cbranch_scc1 L_pw2
    s_waitcnt lgkmcnt(10)
    v_mfma_f32_16x16x32_bf16 v[160:163], v[212:215], v[92:95], v[160:163]
    v_mfma_f32_16x16x32_bf16 v[164:167], v[224:227], v[92:95], v[164:167]
    s_waitcnt lgkmcnt(8)
    v_mfma_f32_16x16x32_bf16 v[168:171], v[212:215], v[104:107], v[168:171]
    v_mfma_f32_16x16x32_bf16 v[172:175], v[224:227], v[104:107], v[172:175]
    s_waitcnt lgkmcnt(6)
    v_mfma_f32_16x16x32_bf16 v[176:179], v[212:215], v[116:119], v[176:179]
    v_mfma_f32_16x16x32_bf16 v[180:183], v[224:227], v[116:119], v[180:183]
    s_waitcnt lgkmcnt(4)
    v_mfma_f32_16x16x32_bf16 v[184:187], v[212:215], v[128:131], v[184:187]
    v_mfma_f32_16x16x32_bf16 v[188:191], v[224:227], v[128:131], v[188:191]
    s_waitcnt lgkmcnt(2)
    v_mfma_f32_16x16x32_bf16 v[192:195], v[212:215], v[140:143], v[192:195]
    v_mfma_f32_16x16x32_bf16 v[196:199], v[224:227], v[140:143], v[196:199]
    s_waitcnt lgkmcnt(0)
    v_mfma_f32_16x16x32_bf16 v[200:203], v[212:215], v[152:155], v[200:203]
    v_mfma_f32_16x16x32_bf16 v[204:207], v[224:227], v[152:155], v[204:207]
L_pw2:
    ds_read_b32 v6, v5 offset:0
    s_waitcnt lgkmcnt(0)
    v_readfirstlane_b32 s29, v6
    s_cmp_ge_u32 s29, 3
    s_cbranch_scc1 L_pw2_ok
    s_sleep 1
    s_branch L_pw2
L_pw2_ok:
    ds_read_b64_tr_b16 v[96:97], v9 offset:12288
    ds_read_b64_tr_b16 v[98:99], v9 offset:13056
    ds_read_b64_tr_b16 v[108:109], v9 offset:12296
    ds_read_b64_tr_b16 v[110:111], v9 offset:13064
    ds_read_b64_tr_b16 v[120:121], v9 offset:12352
    ds_read_b64_tr_b16 v[122:123], v9 offset:13120
    ds_read_b64_tr_b16 v[132:133], v9 offset:12360
    ds_read_b64_tr_b16 v[134:135], v9 offset:13128
    ds_read_b64_tr_b16 v[144:145], v9 offset:12416
    ds_read_b64_tr_b16 v[146:147], v9 offset:13184
    ds_read_b64_tr_b16 v[156:157], v9 offset:12424
    ds_read_b64_tr_b16 v[158:159], v9 offset:13192
    s_cmp_eq_u32 s28, 3
    s_cbranch_scc1 L_wfdone
    s_waitcnt lgkmcnt(10)
    v_mfma_f32_16x16x32_bf16 v[160:163], v[216:219], v[96:99], v[160:163]
    v_mfma_f32_16x16x32_bf16 v[164:167], v[228:231], v[96:99], v[164:167]
    s_waitcnt lgkmcnt(8)
    v_mfma_f32_16x16x32_bf16 v[168:171], v[216:219], v[108:111], v[168:171]
    v_mfma_f32_16x16x32_bf16 v[172:175], v[228:231], v[108:111], v[172:175]
    s_waitcnt lgkmcnt(6)
    v_mfma_f32_16x16x32_bf16 v[176:179], v[216:219], v[120:123], v[176:179]
    v_mfma_f32_16x16x32_bf16 v[180:183], v[228:231], v[120:123], v[180:183]
    s_waitcnt lgkmcnt(4)
    v_mfma_f32_16x16x32_bf16 v[184:187], v[216:219], v[132:135], v[184:187]
    v_mfma_f32_16x16x32_bf16 v[188:191], v[228:231], v[132:135], v[188:191]
    s_waitcnt lgkmcnt(2)
    v_mfma_f32_16x16x32_bf16 v[192:195], v[216:219], v[144:147], v[192:195]
    v_mfma_f32_16x16x32_bf16 v[196:199], v[228:231], v[144:147], v[196:199]
    s_waitcnt lgkmcnt(0)
    v_mfma_f32_16x16x32_bf16 v[200:203], v[216:219], v[156:159], v[200:203]
    v_mfma_f32_16x16x32_bf16 v[204:207], v[228:231], v[156:159], v[204:207]
    v_cvt_pk_bf16_f32 v160, v160, v161
    v_cvt_pk_bf16_f32 v161, v162, v163
    v_cvt_pk_bf16_f32 v162, v164, v165
    v_cvt_pk_bf16_f32 v163, v166, v167
    ds_write_b128 v8, v[160:163] offset:0
    v_cvt_pk_bf16_f32 v168, v168, v169
    v_cvt_pk_bf16_f32 v169, v170, v171
    v_cvt_pk_bf16_f32 v170, v172, v173
    v_cvt_pk_bf16_f32 v171, v174, v175
    ds_write_b128 v8, v[168:171] offset:1024
    v_cvt_pk_bf16_f32 v176, v176, v177
    v_cvt_pk_bf16_f32 v177, v178, v179
    v_cvt_pk_bf16_f32 v178, v180, v181
    v_cvt_pk_bf16_f32 v179, v182, v183
    ds_write_b128 v8, v[176:179] offset:2048
    v_cvt_pk_bf16_f32 v184, v184, v185
    v_cvt_pk_bf16_f32 v185, v186, v187
    v_cvt_pk_bf16_f32 v186, v188, v189
    v_cvt_pk_bf16_f32 v187, v190, v191
    ds_write_b128 v8, v[184:187] offset:3072
    v_cvt_pk_bf16_f32 v192, v192, v193
    v_cvt_pk_bf16_f32 v193, v194, v195
    v_cvt_pk_bf16_f32 v194, v196, v197
    v_cvt_pk_bf16_f32 v195, v198, v199
    ds_write_b128 v8, v[192:195] offset:4096
    v_cvt_pk_bf16_f32 v200, v200, v201
    v_cvt_pk_bf16_f32 v201, v202, v203
    v_cvt_pk_bf16_f32 v202, v204, v205
    v_cvt_pk_bf16_f32 v203, v206, v207
    ds_write_b128 v8, v[200:203] offset:5120
    s_waitcnt lgkmcnt(0)
    s_mov_b64 exec, 1
    ds_add_u32 v5, v12 offset:4
    s_mov_b64 exec, -1
L_wfdone:
    s_waitcnt lgkmcnt(0)
    s_mov_b64 exec, 1
    ds_add_u32 v5, v12 offset:8
    s_mov_b64 exec, -1
L_whole:
    s_cmp_ge_u32 s29, s31
    s_cbranch_scc1 L_w0_ok
L_w0:
    ds_read_b32 v6, v5 offset:0
    s_waitcnt lgkmcnt(0)
    v_readfirstlane_b32 s29, v6
    s_cmp_ge_u32 s29, s31
    s_cbranch_scc1 L_w0_ok
    s_sleep 1
    s_branch L_w0
L_w0_ok:
    ds_read_b128 v[232:235], v15 offset:0
    ds_read_b128 v[236:239], v15 offset:64
    ds_read_b128 v[240:243], v15 offset:128
    s_waitcnt lgkmcnt(0)
    v_mfma_f32_16x16x32_bf16 v[160:163], v[88:91], v[232:235], 0
    v_mfma_f32_16x16x32_bf16 v[164:167], v[100:103], v[232:235], 0
    v_mfma_f32_16x16x32_bf16 v[168:171], v[112:115], v[232:235], 0
    v_mfma_f32_16x16x32_bf16 v[172:175], v[124:127], v[232:235], 0
    v_mfma_f32_16x16x32_bf16 v[176:179], v[136:139], v[232:235], 0
    v_mfma_f32_16x16x32_bf16 v[180:183], v[148:151], v[232:235], 0
    v_mfma_f32_16x16x32_bf16 v[160:163], v[92:95], v[236:239], v[160:163]
    v_mfma_f32_16x16x32_bf16 v[164:167], v[104:107], v[236:239], v[164:167]
    v_mfma_f32_16x16x32_bf16 v[168:171], v[116:119], v[236:239], v[168:171]
    v_mfma_f32_16x16x32_bf16 v[172:175], v[128:131], v[236:239], v[172:175]
    v_mfma_f32_16x16x32_bf16 v[176:179], v[140:143], v[236:239], v[176:179]
    v_mfma_f32_16x16x32_bf16 v[180:183], v[152:155], v[236:239], v[180:183]
    v_mfma_f32_16x16x32_bf16 v[160:163], v[96:99], v[240:243], v[160:163]
    v_mfma_f32_16x16x32_bf16 v[164:167], v[108:111], v[240:243], v[164:167]
    v_mfma_f32_16x16x32_bf16 v[168:171], v[120:123], v[240:243], v[168:171]
    v_mfma_f32_16x16x32_bf16 v[172:175], v[132:135], v[240:243], v[172:175]
    v_mfma_f32_16x16x32_bf16 v[176:179], v[144:147], v[240:243], v[176:179]
    v_mfma_f32_16x16x32_bf16 v[180:183], v[156:159], v[240:243], v[180:183]
    s_cmp_lt_u32 s30, 8
    s_cbranch_scc1 L_getwf
L_gotwf:
    s_add_u32 s31, s31, 1
    s_add_u32 s30, s30, 1
    s_cmp_ge_u32 s29, s31
    s_cbranch_scc1 L_w1_ok
L_w1:
    ds_read_b32 v6, v5 offset:0
    s_waitcnt lgkmcnt(0)
    v_readfirstlane_b32 s29, v6
    s_cmp_ge_u32 s29, s31
    s_cbranch_scc1 L_w1_ok
    s_sleep 1
    s_branch L_w1
L_w1_ok:
    ds_read_b128 v[208:211], v13 offset:3072
    ds_read_b128 v[212:215], v14 offset:3072
    ds_read_b128 v[216:219], v13 offset:3200
    ds_read_b128 v[220:223], v14 offset:3200
    ds_read_b128 v[224:227], v13 offset:3328
    ds_read_b128 v[228:231], v14 offset:3328
    s_waitcnt lgkmcnt(3)
    v_mfma_f32_16x16x32_bf16 v[184:187], v[16:19], v[208:211], v[160:163]
    v_mfma_f32_16x16x32_bf16 v[188:191], v[28:31], v[208:211], v[164:167]
    v_mfma_f32_16x16x32_bf16 v[192:195], v[40:43], v[208:211], v[168:171]
    v_mfma_f32_16x16x32_bf16 v[196:199], v[52:55], v[208:211], v[172:175]
    v_mfma_f32_16x16x32_bf16 v[200:203], v[64:67], v[208:211], v[176:179]
    v_mfma_f32_16x16x32_bf16 v[204:207], v[76:79], v[208:211], v[180:183]
    v_mfma_f32_16x16x32_bf16 v[184:187], v[20:23], v[212:215], v[184:187]
    v_mfma_f32_16x16x32_bf16 v[188:191], v[32:35], v[212:215], v[188:191]
    v_mfma_f32_16x16x32_bf16 v[192:195], v[44:47], v[212:215], v[192:195]
    v_mfma_f32_16x16x32_bf16 v[196:199], v[56:59], v[212:215], v[196:199]
    v_mfma_f32_16x16x32_bf16 v[200:203], v[68:71], v[212:215], v[200:203]
    v_mfma_f32_16x16x32_bf16 v[204:207], v[80:83], v[212:215], v[204:207]
    v_mfma_f32_16x16x32_bf16 v[184:187], v[24:27], v[216:219], v[184:187]
    v_mfma_f32_16x16x32_bf16 v[188:191], v[36:39], v[216:219], v[188:191]
    v_mfma_f32_16x16x32_bf16 v[192:195], v[48:51], v[216:219], v[192:195]
    v_mfma_f32_16x16x32_bf16 v[196:199], v[60:63], v[216:219], v[196:199]
    v_mfma_f32_16x16x32_bf16 v[200:203], v[72:75], v[216:219], v[200:203]
    v_mfma_f32_16x16x32_bf16 v[204:207], v[84:87], v[216:219], v[204:207]
    v_mov_b32 v6, s30
    s_nop 1
    v_cvt_pk_bf16_f32 v208, v184, v185
    v_cvt_pk_bf16_f32 v209, v186, v187
    v_cvt_pk_bf16_f32 v210, v188, v189
    v_cvt_pk_bf16_f32 v211, v190, v191
    ds_write_b128 v13, v[208:211] offset:3072
    v_cvt_pk_bf16_f32 v212, v192, v193
    v_cvt_pk_bf16_f32 v213, v194, v195
    v_cvt_pk_bf16_f32 v214, v196, v197
    v_cvt_pk_bf16_f32 v215, v198, v199
    ds_write_b128 v14, v[212:215] offset:3072
    v_cvt_pk_bf16_f32 v216, v200, v201
    v_cvt_pk_bf16_f32 v217, v202, v203
    v_cvt_pk_bf16_f32 v218, v204, v205
    v_cvt_pk_bf16_f32 v219, v206, v207
    ds_write_b128 v13, v[216:219] offset:3200
    s_waitcnt lgkmcnt(3)
    v_mfma_f32_16x16x32_bf16 v[184:187], v[16:19], v[220:223], v[160:163]
    v_mfma_f32_16x16x32_bf16 v[188:191], v[28:31], v[220:223], v[164:167]
    v_mfma_f32_16x16x32_bf16 v[192:195], v[40:43], v[220:223], v[168:171]
    v_mfma_f32_16x16x32_bf16 v[196:199], v[52:55], v[220:223], v[172:175]
    v_mfma_f32_16x16x32_bf16 v[200:203], v[64:67], v[220:223], v[176:179]
    v_mfma_f32_16x16x32_bf16 v[204:207], v[76:79], v[220:223], v[180:183]
    v_mfma_f32_16x16x32_bf16 v[184:187], v[20:23], v[224:227], v[184:187]
    v_mfma_f32_16x16x32_bf16 v[188:191], v[32:35], v[224:227], v[188:191]
    v_mfma_f32_16x16x32_bf16 v[192:195], v[44:47], v[224:227], v[192:195]
    v_mfma_f32_16x16x32_bf16 v[196:199], v[56:59], v[224:227], v[196:199]
    v_mfma_f32_16x16x32_bf16 v[200:203], v[68:71], v[224:227], v[200:203]
    v_mfma_f32_16x16x32_bf16 v[204:207], v[80:83], v[224:227], v[204:207]
    v_mfma_f32_16x16x32_bf16 v[184:187], v[24:27], v[228:231], v[184:187]
    v_mfma_f32_16x16x32_bf16 v[188:191], v[36:39], v[228:231], v[188:191]
    v_mfma_f32_16x16x32_bf16 v[192:195], v[48:51], v[228:231], v[192:195]
    v_mfma_f32_16x16x32_bf16 v[196:199], v[60:63], v[228:231], v[196:199]
    v_mfma_f32_16x16x32_bf16 v[200:203], v[72:75], v[228:231], v[200:203]
    v_mfma_f32_16x16x32_bf16 v[204:207], v[84:87], v[228:231], v[204:207]
    v_mov_b32 v6, s30
    s_nop 1
    v_cvt_pk_bf16_f32 v220, v184, v185
    v_cvt_pk_bf16_f32 v221, v186, v187
    v_cvt_pk_bf16_f32 v222, v188, v189
    v_cvt_pk_bf16_f32 v223, v190, v191
    ds_write_b128 v14, v[220:223] offset:3200
    v_cvt_pk_bf16_f32 v224, v192, v193
    v_cvt_pk_bf16_f32 v225, v194, v195
    v_cvt_pk_bf16_f32 v226, v196, v197
    v_cvt_pk_bf16_f32 v227, v198, v199
    ds_write_b128 v13, v[224:227] offset:3328
    v_cvt_pk_bf16_f32 v228, v200, v201
    v_cvt_pk_bf16_f32 v229, v202, v203
    v_cvt_pk_bf16_f32 v230, v204, v205
    v_cvt_pk_bf16_f32 v231, v206, v207
    ds_write_b128 v14, v[228:231] offset:3328
    s_waitcnt lgkmcnt(0)
    ds_write_b32 v10, v6 offset:16
    s_add_u32 s31, s31, 1
    s_add_u32 s30, s30, 1
    s_cmp_ge_u32 s29, s31
    s_cbranch_scc1 L_w2_ok
L_w2:
    ds_read_b32 v6, v5 offset:0
    s_waitcnt lgkmcnt(0)
    v_readfirstlane_b32 s29, v6
    s_cmp_ge_u32 s29, s31
    s_cbranch_scc1 L_w2_ok
    s_sleep 1
    s_branch L_w2
L_w2_ok:
    ds_read_b128 v[208:211], v13 offset:9216
    ds_read_b128 v[212:215], v14 offset:9216
    ds_read_b128 v[216:219], v13 offset:9344
    ds_read_b128 v[220:223], v14 offset:9344
    ds_read_b128 v[224:227], v13 offset:9472
    ds_read_b128 v[228:231], v14 offset:9472
    s_waitcnt lgkmcnt(3)
    v_mfma_f32_16x16x32_bf16 v[184:187], v[16:19], v[208:211], v[160:163]
    v_mfma_f32_16x16x32_bf16 v[188:191], v[28:31], v[208:211], v[164:167]
    v_mfma_f32_16x16x32_bf16 v[192:195], v[40:43], v[208:211], v[168:171]
    v_mfma_f32_16x16x32_bf16 v[196:199], v[52:55], v[208:211], v[172:175]
    v_mfma_f32_16x16x32_bf16 v[200:203], v[64:67], v[208:211], v[176:179]
    v_mfma_f32_16x16x32_bf16 v[204:207], v[76:79], v[208:211], v[180:183]
    v_mfma_f32_16x16x32_bf16 v[184:187], v[20:23], v[212:215], v[184:187]
    v_mfma_f32_16x16x32_bf16 v[188:191], v[32:35], v[212:215], v[188:191]
    v_mfma_f32_16x16x32_bf16 v[192:195], v[44:47], v[212:215], v[192:195]
    v_mfma_f32_16x16x32_bf16 v[196:199], v[56:59], v[212:215], v[196:199]
    v_mfma_f32_16x16x32_bf16 v[200:203], v[68:71], v[212:215], v[200:203]
    v_mfma_f32_16x16x32_bf16 v[204:207], v[80:83], v[212:215], v[204:207]
    v_mfma_f32_16x16x32_bf16 v[184:187], v[24:27], v[216:219], v[184:187]
    v_mfma_f32_16x16x32_bf16 v[188:191], v[36:39], v[216:219], v[188:191]
    v_mfma_f32_16x16x32_bf16 v[192:195], v[48:51], v[216:219], v[192:195]
    v_mfma_f32_16x16x32_bf16 v[196:199], v[60:63], v[216:219], v[196:199]
    v_mfma_f32_16x16x32_bf16 v[200:203], v[72:75], v[216:219], v[200:203]
    v_mfma_f32_16x16x32_bf16 v[204:207], v[84:87], v[216:219], v[204:207]
    v_mov_b32 v6, s30
    s_nop 1
    v_cvt_pk_bf16_f32 v208, v184, v185
    v_cvt_pk_bf16_f32 v209, v186, v187
    v_cvt_pk_bf16_f32 v210, v188, v189
    v_cvt_pk_bf16_f32 v211, v190, v191
    ds_write_b128 v13, v[208:211] offset:9216
    v_cvt_pk_bf16_f32 v212, v192, v193
    v_cvt_pk_bf16_f32 v213, v194, v195
    v_cvt_pk_bf16_f32 v214, v196, v197
    v_cvt_pk_bf16_f32 v215, v198, v199
    ds_write_b128 v14, v[212:215] offset:9216
    v_cvt_pk_bf16_f32 v216, v200, v201
    v_cvt_pk_bf16_f32 v217, v202, v203
    v_cvt_pk_bf16_f32 v218, v204, v205
    v_cvt_pk_bf16_f32 v219, v206, v207
    ds_write_b128 v13, v[216:219] offset:9344
    s_waitcnt lgkmcnt(3)
    v_mfma_f32_16x16x32_bf16 v[184:187], v[16:19], v[220:223], v[160:163]
    v_mfma_f32_16x16x32_bf16 v[188:191], v[28:31], v[220:223], v[164:167]
    v_mfma_f32_16x16x32_bf16 v[192:195], v[40:43], v[220:223], v[168:171]
    v_mfma_f32_16x16x32_bf16 v[196:199], v[52:55], v[220:223], v[172:175]
    v_mfma_f32_16x16x32_bf16 v[200:203], v[64:67], v[220:223], v[176:179]
    v_mfma_f32_16x16x32_bf16 v[204:207], v[76:79], v[220:223], v[180:183]
    v_mfma_f32_16x16x32_bf16 v[184:187], v[20:23], v[224:227], v[184:187]
    v_mfma_f32_16x16x32_bf16 v[188:191], v[32:35], v[224:227], v[188:191]
    v_mfma_f32_16x16x32_bf16 v[192:195], v[44:47], v[224:227], v[192:195]
    v_mfma_f32_16x16x32_bf16 v[196:199], v[56:59], v[224:227], v[196:199]
    v_mfma_f32_16x16x32_bf16 v[200:203], v[68:71], v[224:227], v[200:203]
    v_mfma_f32_16x16x32_bf16 v[204:207], v[80:83], v[224:227], v[204:207]
    v_mfma_f32_16x16x32_bf16 v[184:187], v[24:27], v[228:231], v[184:187]
    v_mfma_f32_16x16x32_bf16 v[188:191], v[36:39], v[228:231], v[188:191]
    v_mfma_f32_16x16x32_bf16 v[192:195], v[48:51], v[228:231], v[192:195]
    v_mfma_f32_16x16x32_bf16 v[196:199], v[60:63], v[228:231], v[196:199]
    v_mfma_f32_16x16x32_bf16 v[200:203], v[72:75], v[228:231], v[200:203]
    v_mfma_f32_16x16x32_bf16 v[204:207], v[84:87], v[228:231], v[204:207]
    v_mov_b32 v6, s30
    s_nop 1
    v_cvt_pk_bf16_f32 v220, v184, v185
    v_cvt_pk_bf16_f32 v221, v186, v187
    v_cvt_pk_bf16_f32 v222, v188, v189
    v_cvt_pk_bf16_f32 v223, v190, v191
    ds_write_b128 v14, v[220:223] offset:9344
    v_cvt_pk_bf16_f32 v224, v192, v193
    v_cvt_pk_bf16_f32 v225, v194, v195
    v_cvt_pk_bf16_f32 v226, v196, v197
    v_cvt_pk_bf16_f32 v227, v198, v199
    ds_write_b128 v13, v[224:227] offset:9472
    v_cvt_pk_bf16_f32 v228, v200, v201
    v_cvt_pk_bf16_f32 v229, v202, v203
    v_cvt_pk_bf16_f32 v230, v204, v205
    v_cvt_pk_bf16_f32 v231, v206, v207
    ds_write_b128 v14, v[228:231] offset:9472
    s_waitcnt lgkmcnt(0)
    ds_write_b32 v10, v6 offset:16
    v_add_u32 v13, s33, v13
    v_add_u32 v14, s33, v14
    v_add_u32 v15, s33, v15
    s_mov_b32 s33, s34
    s_add_u32 s31, s31, 10
    s_add_u32 s30, s30, 6
    s_cmp_lt_u32 s30, 24
    s_cbranch_scc1 L_whole
    s_mov_b32 s30, 24
    s_mov_b32 s31, 40
L_unit:
    s_cmp_ge_u32 s29, s31
    s_cbranch_scc1 L_pc1_ok
L_pc1:
    ds_read_b32 v6, v5 offset:0
    s_waitcnt lgkmcnt(0)
    v_readfirstlane_b32 s29, v6
    s_cmp_ge_u32 s29, s31
    s_cbranch_scc1 L_pc1_ok
    s_sleep 1
    s_branch L_pc1
L_pc1_ok:
    ds_read_b128 v[208:211], v4 offset:0
    ds_read_b128 v[212:215], v4 offset:64
    ds_read_b128 v[216:219], v4 offset:128
    s_add_u32 s32, s31, s6
    s_waitcnt lgkmcnt(0)
    v_mfma_f32_16x16x32_bf16 v[160:163], v[88:91], v[208:211], 0
    v_mfma_f32_16x16x32_bf16 v[164:167], v[100:103], v[208:211], 0
    v_mfma_f32_16x16x32_bf16 v[168:171], v[112:115], v[208:211], 0
    v_mfma_f32_16x16x32_bf16 v[172:175], v[124:127], v[208:211], 0
    v_mfma_f32_16x16x32_bf16 v[176:179], v[136:139], v[208:211], 0
    v_mfma_f32_16x16x32_bf16 v[180:183], v[148:151], v[208:211], 0
    v_mfma_f32_16x16x32_bf16 v[160:163], v[92:95], v[212:215], v[160:163]
    v_mfma_f32_16x16x32_bf16 v[164:167], v[104:107], v[212:215], v[164:167]
    v_mfma_f32_16x16x32_bf16 v[168:171], v[116:119], v[212:215], v[168:171]
    v_mfma_f32_16x16x32_bf16 v[172:175], v[128:131], v[212:215], v[172:175]
    v_mfma_f32_16x16x32_bf16 v[176:179], v[140:143], v[212:215], v[176:179]
    v_mfma_f32_16x16x32_bf16 v[180:183], v[152:155], v[212:215], v[180:183]
    v_mfma_f32_16x16x32_bf16 v[160:163], v[96:99], v[216:219], v[160:163]
    v_mfma_f32_16x16x32_bf16 v[164:167], v[108:111], v[216:219], v[164:167]
    v_mfma_f32_16x16x32_bf16 v[168:171], v[120:123], v[216:219], v[168:171]
    v_mfma_f32_16x16x32_bf16 v[172:175], v[132:135], v[216:219], v[172:175]
    v_mfma_f32_16x16x32_bf16 v[176:179], v[144:147], v[216:219], v[176:179]
    v_mfma_f32_16x16x32_bf16 v[180:183], v[156:159], v[216:219], v[180:183]
    s_cmp_ge_u32 s29, s32
    s_cbranch_scc1 L_pc2_ok
L_pc2:
    ds_read_b32 v6, v5 offset:0
    s_waitcnt lgkmcnt(0)
    v_readfirstlane_b32 s29, v6
    s_cmp_ge_u32 s29, s32
    s_cbranch_scc1 L_pc2_ok
    s_sleep 1
    s_branch L_pc2
L_pc2_ok:
    ds_read_b128 v[220:223], v1
    ds_read_b128 v[224:227], v2
    ds_read_b128 v[228:231], v3
    s_add_u32 s30, s30, 2
    s_add_u32 s31, s31, 3
    s_waitcnt lgkmcnt(2)
    v_mfma_f32_16x16x32_bf16 v[160:163], v[16:19], v[220:223], v[160:163]
    v_mfma_f32_16x16x32_bf16 v[164:167], v[28:31], v[220:223], v[164:167]
    v_mfma_f32_16x16x32_bf16 v[168:171], v[40:43], v[220:223], v[168:171]
    v_mfma_f32_16x16x32_bf16 v[172:175], v[52:55], v[220:223], v[172:175]
    v_mfma_f32_16x16x32_bf16 v[176:179], v[64:67], v[220:223], v[176:179]
    v_mfma_f32_16x16x32_bf16 v[180:183], v[76:79], v[220:223], v[180:183]
    s_waitcnt lgkmcnt(1)
    v_mfma_f32_16x16x32_bf16 v[160:163], v[20:23], v[224:227], v[160:163]
    v_mfma_f32_16x16x32_bf16 v[164:167], v[32:35], v[224:227], v[164:167]
    v_mfma_f32_16x16x32_bf16 v[168:171], v[44:47], v[224:227], v[168:171]
    v_mfma_f32_16x16x32_bf16 v[172:175], v[56:59], v[224:227], v[172:175]
    v_mfma_f32_16x16x32_bf16 v[176:179], v[68:71], v[224:227], v[176:179]
    v_mfma_f32_16x16x32_bf16 v[180:183], v[80:83], v[224:227], v[180:183]
    s_waitcnt lgkmcnt(0)
    v_mfma_f32_16x16x32_bf16 v[160:163], v[24:27], v[228:231], v[160:163]
    v_mfma_f32_16x16x32_bf16 v[164:167], v[36:39], v[228:231], v[164:167]
    v_mfma_f32_16x16x32_bf16 v[168:171], v[48:51], v[228:231], v[168:171]
    v_mfma_f32_16x16x32_bf16 v[172:175], v[60:63], v[228:231], v[172:175]
    v_mfma_f32_16x16x32_bf16 v[176:179], v[72:75], v[228:231], v[176:179]
    v_mfma_f32_16x16x32_bf16 v[180:183], v[84:87], v[228:231], v[180:183]
    v_mov_b32 v6, s30
    s_cmp_eq_u32 s30, 18
    s_cselect_b32 s32, 4294829056, 0
    v_cvt_pk_bf16_f32 v232, v160, v161
    v_cvt_pk_bf16_f32 v233, v162, v163
    v_cvt_pk_bf16_f32 v234, v164, v165
    v_cvt_pk_bf16_f32 v235, v166, v167
    ds_write_b128 v1, v[232:235]
    v_cvt_pk_bf16_f32 v236, v168, v169
    v_cvt_pk_bf16_f32 v237, v170, v171
    v_cvt_pk_bf16_f32 v238, v172, v173
    v_cvt_pk_bf16_f32 v239, v174, v175
    ds_write_b128 v2, v[236:239]
    v_cvt_pk_bf16_f32 v240, v176, v177
    v_cvt_pk_bf16_f32 v241, v178, v179
    v_cvt_pk_bf16_f32 v242, v180, v181
    v_cvt_pk_bf16_f32 v243, v182, v183
    ds_write_b128 v3, v[240:243]
    s_add_u32 s32, s32, 15360
    s_waitcnt lgkmcnt(0)
    ds_write_b32 v10, v6 offset:16
    v_add_u32 v1, s32, v1
    v_add_u32 v2, s32, v2
    v_add_u32 v3, s32, v3
    v_add_u32 v4, s32, v4
    s_cmp_lt_u32 s30, 28
    s_cbranch_scc1 L_unit
    s_lshr_b32 s32, s28, 1
    s_lshl_b32 s33, s32, 3
    v_bfe_u32 v8, v0, 1, 3
    v_lshlrev_b32 v9, 4, v8
    v_add_u32 v8, s33, v8
    v_mul_u32_u24 v8, 192, v8
    v_and_b32 v11, 48, v0
    v_add_u32 v4, v8, v11
    v_add_u32 v8, v8, v4
    v_add_u32 v4, 76800, v4
    v_and_b32 v11, 1, v0
    v_mul_u32_u24 v11, 192, v11
    v_add_u32 v8, v8, v11
    s_and_b32 s34, s28, 1
    s_mul_i32 s35, s34, 6144
    s_add_u32 s35, s35, 79872
    v_add_u32 v11, 0, v8
    v_xor_b32 v11, v11, v9
    v_add_u32 v1, s35, v11
    v_add_u32 v11, 64, v8
    v_xor_b32 v11, v11, v9
    v_add_u32 v2, s35, v11
    v_add_u32 v11, 128, v8
    v_xor_b32 v11, v11, v9
    v_add_u32 v3, s35, v11
    s_mul_i32 s33, s32, 3072
    v_and_b32 v11, 15, v0
    v_mul_u32_u24 v12, 192, v11
    v_and_b32 v8, 48, v0
    v_add3_u32 v12, v12, v8, s33
    s_lshl_b32 s36, s32, 4
    v_add_u32 v11, s36, v11
    v_sub_u32 v8, 11, v11
    v_lshrrev_b32 v8, 31, v8
    v_sub_u32 v9, 23, v11
    v_lshrrev_b32 v9, 31, v9
    v_add_lshl_u32 v10, v8, v9, 1
    v_lshlrev_b32 v8, 10, v10
    v_sub_u32 v8, 2048, v8
    v_add_u32 v12, v12, v8
    s_mul_i32 s34, s34, 98304
    s_sub_u32 s16, s16, 2304
    s_subb_u32 s17, s17, 0
    s_mov_b32 s18, 50333952
    s_mov_b32 s19, 0x20000
    s_add_u32 s31, s28, 47
L_fc:
    ds_read_b32 v6, v5 offset:0
    s_waitcnt lgkmcnt(0)
    v_readfirstlane_b32 s29, v6
    s_cmp_ge_u32 s29, 46
    s_cbranch_scc1 L_fc_ok
    s_sleep 1
    s_branch L_fc
L_fc_ok:
    ds_read_b128 v[232:235], v5 offset:32
    ds_read_b128 v[208:211], v4 offset:0
    ds_read_b128 v[212:215], v4 offset:64
    ds_read_b128 v[216:219], v4 offset:128
    ds_read_b128 v[220:223], v4 offset:15360
    ds_read_b128 v[224:227], v4 offset:15424
    ds_read_b128 v[228:231], v4 offset:15488
    s_waitcnt lgkmcnt(3)
    v_readfirstlane_b32 s36, v232
    v_readfirstlane_b32 s37, v233
    v_readfirstlane_b32 s38, v234
    v_readfirstlane_b32 s39, v235
    v_mfma_f32_16x16x32_bf16 v[160:163], v[88:91], v[208:211], 0
    v_mfma_f32_16x16x32_bf16 v[164:167], v[100:103], v[208:211], 0
    v_mfma_f32_16x16x32_bf16 v[168:171], v[112:115], v[208:211], 0
    v_mfma_f32_16x16x32_bf16 v[172:175], v[124:127], v[208:211], 0
    v_mfma_f32_16x16x32_bf16 v[176:179], v[136:139], v[208:211], 0
    v_mfma_f32_16x16x32_bf16 v[180:183], v[148:151], v[208:211], 0
    v_mfma_f32_16x16x32_bf16 v[160:163], v[92:95], v[212:215], v[160:163]
    v_mfma_f32_16x16x32_bf16 v[164:167], v[104:107], v[212:215], v[164:167]
    v_mfma_f32_16x16x32_bf16 v[168:171], v[116:119], v[212:215], v[168:171]
    v_mfma_f32_16x16x32_bf16 v[172:175], v[128:131], v[212:215], v[172:175]
    v_mfma_f32_16x16x32_bf16 v[176:179], v[140:143], v[212:215], v[176:179]
    v_mfma_f32_16x16x32_bf16 v[180:183], v[152:155], v[212:215], v[180:183]
    v_mfma_f32_16x16x32_bf16 v[160:163], v[96:99], v[216:219], v[160:163]
    v_mfma_f32_16x16x32_bf16 v[164:167], v[108:111], v[216:219], v[164:167]
    v_mfma_f32_16x16x32_bf16 v[168:171], v[120:123], v[216:219], v[168:171]
    v_mfma_f32_16x16x32_bf16 v[172:175], v[132:135], v[216:219], v[172:175]
    v_mfma_f32_16x16x32_bf16 v[176:179], v[144:147], v[216:219], v[176:179]
    v_mfma_f32_16x16x32_bf16 v[180:183], v[156:159], v[216:219], v[180:183]
    s_waitcnt lgkmcnt(0)
    v_mfma_f32_16x16x32_bf16 v[184:187], v[88:91], v[220:223], 0
    v_mfma_f32_16x16x32_bf16 v[188:191], v[100:103], v[220:223], 0
    v_mfma_f32_16x16x32_bf16 v[192:195], v[112:115], v[220:223], 0
    v_mfma_f32_16x16x32_bf16 v[196:199], v[124:127], v[220:223], 0
    v_mfma_f32_16x16x32_bf16 v[200:203], v[136:139], v[220:223], 0
    v_mfma_f32_16x16x32_bf16 v[204:207], v[148:151], v[220:223], 0
    v_mfma_f32_16x16x32_bf16 v[184:187], v[92:95], v[224:227], v[184:187]
    v_mfma_f32_16x16x32_bf16 v[188:191], v[104:107], v[224:227], v[188:191]
    v_mfma_f32_16x16x32_bf16 v[192:195], v[116:119], v[224:227], v[192:195]
    v_mfma_f32_16x16x32_bf16 v[196:199], v[128:131], v[224:227], v[196:199]
    v_mfma_f32_16x16x32_bf16 v[200:203], v[140:143], v[224:227], v[200:203]
    v_mfma_f32_16x16x32_bf16 v[204:207], v[152:155], v[224:227], v[204:207]
    v_mfma_f32_16x16x32_bf16 v[184:187], v[96:99], v[228:231], v[184:187]
    v_mfma_f32_16x16x32_bf16 v[188:191], v[108:111], v[228:231], v[188:191]
    v_mfma_f32_16x16x32_bf16 v[192:195], v[120:123], v[228:231], v[192:195]
    v_mfma_f32_16x16x32_bf16 v[196:199], v[132:135], v[228:231], v[196:199]
    v_mfma_f32_16x16x32_bf16 v[200:203], v[144:147], v[228:231], v[200:203]
    v_mfma_f32_16x16x32_bf16 v[204:207], v[156:159], v[228:231], v[204:207]
    s_add_u32 s36, s36, s34
    s_add_u32 s38, s38, s34
    v_bfe_u32 v250, s37, v10, 2
    v_lshl_add_u32 v250, v250, 15, v12
    s_cmp_ge_u32 s29, s31
    s_cbranch_scc1 L_f0_ok
L_f0:
    ds_read_b32 v6, v5 offset:0
    s_waitcnt lgkmcnt(0)
    v_readfirstlane_b32 s29, v6
    s_cmp_ge_u32 s29, s31
    s_cbranch_scc1 L_f0_ok
    s_sleep 1
    s_branch L_f0
L_f0_ok:
    ds_read_b128 v[208:211], v1 offset:0
    ds_read_b128 v[212:215], v2 offset:0
    ds_read_b128 v[216:219], v3 offset:0
    s_waitcnt lgkmcnt(2)
    v_mfma_f32_16x16x32_bf16 v[160:163], v[16:19], v[208:211], v[160:163]
    v_mfma_f32_16x16x32_bf16 v[164:167], v[28:31], v[208:211], v[164:167]
    s_waitcnt lgkmcnt(1)
    v_mfma_f32_16x16x32_bf16 v[160:163], v[20:23], v[212:215], v[160:163]
    v_mfma_f32_16x16x32_bf16 v[164:167], v[32:35], v[212:215], v[164:167]
    s_waitcnt lgkmcnt(0)
    v_mfma_f32_16x16x32_bf16 v[160:163], v[24:27], v[216:219], v[160:163]
    v_mfma_f32_16x16x32_bf16 v[164:167], v[36:39], v[216:219], v[164:167]
    v_mfma_f32_16x16x32_bf16 v[168:171], v[40:43], v[208:211], v[168:171]
    v_mfma_f32_16x16x32_bf16 v[172:175], v[52:55], v[208:211], v[172:175]
    v_mfma_f32_16x16x32_bf16 v[168:171], v[44:47], v[212:215], v[168:171]
    v_mfma_f32_16x16x32_bf16 v[172:175], v[56:59], v[212:215], v[172:175]
    v_mfma_f32_16x16x32_bf16 v[168:171], v[48:51], v[216:219], v[168:171]
    v_mfma_f32_16x16x32_bf16 v[172:175], v[60:63], v[216:219], v[172:175]
    v_mfma_f32_16x16x32_bf16 v[176:179], v[64:67], v[208:211], v[176:179]
    v_mfma_f32_16x16x32_bf16 v[180:183], v[76:79], v[208:211], v[180:183]
    v_cvt_pk_bf16_f32 v232, v160, v161
    v_cvt_pk_bf16_f32 v233, v162, v163
    v_mfma_f32_16x16x32_bf16 v[176:179], v[68:71], v[212:215], v[176:179]
    v_cvt_pk_bf16_f32 v234, v164, v165
    v_cvt_pk_bf16_f32 v235, v166, v167
    v_mfma_f32_16x16x32_bf16 v[180:183], v[80:83], v[212:215], v[180:183]
    buffer_store_dwordx4 v[232:235], v250, s[16:19], s36 offen offset:0
    v_mfma_f32_16x16x32_bf16 v[176:179], v[72:75], v[216:219], v[176:179]
    v_mfma_f32_16x16x32_bf16 v[180:183], v[84:87], v[216:219], v[180:183]
    v_cvt_pk_bf16_f32 v236, v168, v169
    v_cvt_pk_bf16_f32 v237, v170, v171
    v_cvt_pk_bf16_f32 v238, v172, v173
    v_cvt_pk_bf16_f32 v239, v174, v175
    buffer_store_dwordx4 v[236:239], v250, s[16:19], s36 offen offset:64
    s_add_u32 s31, s31, 4
    s_nop 0
    v_cvt_pk_bf16_f32 v240, v176, v177
    v_cvt_pk_bf16_f32 v241, v178, v179
    v_cvt_pk_bf16_f32 v242, v180, v181
    v_cvt_pk_bf16_f32 v243, v182, v183
    buffer_store_dwordx4 v[240:243], v250, s[16:19], s36 offen offset:128
    v_bfe_u32 v251, s39, v10, 2
    v_lshl_add_u32 v251, v251, 15, v12
L_f1:
    ds_read_b32 v6, v5 offset:0
    ds_read_b128 v[208:211], v1 offset:15360
    ds_read_b128 v[212:215], v2 offset:15360
    ds_read_b128 v[216:219], v3 offset:15360
    s_waitcnt lgkmcnt(3)
    v_readfirstlane_b32 s29, v6
    s_cmp_ge_u32 s29, s31
    s_cbranch_scc0 L_f1
    s_waitcnt lgkmcnt(2)
    v_mfma_f32_16x16x32_bf16 v[184:187], v[16:19], v[208:211], v[184:187]
    v_mfma_f32_16x16x32_bf16 v[188:191], v[28:31], v[208:211], v[188:191]
    s_waitcnt lgkmcnt(1)
    v_mfma_f32_16x16x32_bf16 v[184:187], v[20:23], v[212:215], v[184:187]
    v_mfma_f32_16x16x32_bf16 v[188:191], v[32:35], v[212:215], v[188:191]
    s_waitcnt lgkmcnt(0)
    v_mfma_f32_16x16x32_bf16 v[184:187], v[24:27], v[216:219], v[184:187]
    v_mfma_f32_16x16x32_bf16 v[188:191], v[36:39], v[216:219], v[188:191]
    v_mfma_f32_16x16x32_bf16 v[192:195], v[40:43], v[208:211], v[192:195]
    v_mfma_f32_16x16x32_bf16 v[196:199], v[52:55], v[208:211], v[196:199]
    v_mfma_f32_16x16x32_bf16 v[192:195], v[44:47], v[212:215], v[192:195]
    v_mfma_f32_16x16x32_bf16 v[196:199], v[56:59], v[212:215], v[196:199]
    v_mfma_f32_16x16x32_bf16 v[192:195], v[48:51], v[216:219], v[192:195]
    v_mfma_f32_16x16x32_bf16 v[196:199], v[60:63], v[216:219], v[196:199]
    v_mfma_f32_16x16x32_bf16 v[200:203], v[64:67], v[208:211], v[200:203]
    v_mfma_f32_16x16x32_bf16 v[204:207], v[76:79], v[208:211], v[204:207]
    v_cvt_pk_bf16_f32 v232, v184, v185
    v_cvt_pk_bf16_f32 v233, v186, v187
    v_mfma_f32_16x16x32_bf16 v[200:203], v[68:71], v[212:215], v[200:203]
    v_cvt_pk_bf16_f32 v234, v188, v189
    v_cvt_pk_bf16_f32 v235, v190, v191
    v_mfma_f32_16x16x32_bf16 v[204:207], v[80:83], v[212:215], v[204:207]
    buffer_store_dwordx4 v[232:235], v251, s[16:19], s38 offen offset:0
    v_mfma_f32_16x16x32_bf16 v[200:203], v[72:75], v[216:219], v[200:203]
    v_mfma_f32_16x16x32_bf16 v[204:207], v[84:87], v[216:219], v[204:207]
    v_cvt_pk_bf16_f32 v236, v192, v193
    v_cvt_pk_bf16_f32 v237, v194, v195
    v_cvt_pk_bf16_f32 v238, v196, v197
    v_cvt_pk_bf16_f32 v239, v198, v199
    buffer_store_dwordx4 v[236:239], v251, s[16:19], s38 offen offset:64
    s_add_u32 s31, s31, 4
    s_nop 0
    v_cvt_pk_bf16_f32 v240, v200, v201
    v_cvt_pk_bf16_f32 v241, v202, v203
    v_cvt_pk_bf16_f32 v242, v204, v205
    v_cvt_pk_bf16_f32 v243, v206, v207
    buffer_store_dwordx4 v[240:243], v251, s[16:19], s38 offen offset:128
    s_branch L_fin
L_getwf:
    s_mov_b32 s35, s29
L_pf:
    ds_read_b32 v6, v5 offset:4
    s_waitcnt lgkmcnt(0)
    v_readfirstlane_b32 s29, v6
    s_cmp_ge_u32 s29, 3
    s_cbranch_scc1 L_pf_ok
    s_sleep 1
    s_branch L_pf
L_pf_ok:
    ds_read_b128 v[16:19], v11 offset:0
    ds_read_b128 v[28:31], v11 offset:1024
    ds_read_b128 v[40:43], v11 offset:2048
    ds_read_b128 v[52:55], v11 offset:3072
    ds_read_b128 v[64:67], v11 offset:4096
    ds_read_b128 v[76:79], v11 offset:5120
    ds_read_b128 v[20:23], v11 offset:6144
    ds_read_b128 v[32:35], v11 offset:7168
    ds_read_b128 v[44:47], v11 offset:8192
    ds_read_b128 v[56:59], v11 offset:9216
    ds_read_b128 v[68:71], v11 offset:10240
    ds_read_b128 v[80:83], v11 offset:11264
    ds_read_b128 v[24:27], v11 offset:12288
    ds_read_b128 v[36:39], v11 offset:13312
    ds_read_b128 v[48:51], v11 offset:14336
    ds_read_b128 v[60:63], v11 offset:15360
    ds_read_b128 v[72:75], v11 offset:16384
    ds_read_b128 v[84:87], v11 offset:17408
    s_mov_b32 s29, s35
    s_branch L_gotwf
L_retry2:
    s_sleep 1
    ds_read_b32 v160, v5 offset:20
    s_waitcnt lgkmcnt(0)
    v_readfirstlane_b32 s32, v160
    s_cmp_gt_u32 s32, 2
    s_cbranch_scc0 L_retry2
    ds_read_b32 v160, v5 offset:20
    ds_read_b128 v[112:115], v4 offset:18432
    ds_read_b128 v[116:119], v4 offset:19456
    ds_read_b128 v[120:123], v4 offset:20480
    ds_read_b128 v[124:127], v4 offset:21504
    ds_read_b128 v[128:131], v4 offset:22528
    ds_read_b128 v[132:135], v4 offset:23552
    s_branch L_chk2
L_retry3:
    s_sleep 1
    ds_read_b32 v162, v5 offset:20
    s_waitcnt lgkmcnt(0)
    v_readfirstlane_b32 s32, v162
    s_cmp_gt_u32 s32, 3
    s_cbranch_scc0 L_retry3
    ds_read_b32 v162, v5 offset:20
    ds_read_b128 v[136:139], v4 offset:24576
    ds_read_b128 v[140:143], v4 offset:25600
    ds_read_b128 v[144:147], v4 offset:26624
    ds_read_b128 v[148:151], v4 offset:27648
    ds_read_b128 v[152:155], v4 offset:28672
    ds_read_b128 v[156:159], v4 offset:29696
    s_branch L_chk3
L_retry4:
    s_sleep 1
    ds_read_b32 v160, v5 offset:24
    s_waitcnt lgkmcnt(0)
    v_readfirstlane_b32 s32, v160
    s_cmp_gt_u32 s32, 4
    s_cbranch_scc0 L_retry4
    ds_read_b32 v160, v5 offset:24
    ds_read_b128 v[112:115], v4 offset:33792
    ds_read_b128 v[116:119], v4 offset:34816
    ds_read_b128 v[120:123], v4 offset:35840
    ds_read_b128 v[124:127], v4 offset:36864
    ds_read_b128 v[128:131], v4 offset:37888
    ds_read_b128 v[132:135], v4 offset:38912
    s_branch L_chk4
L_retry5:
    s_sleep 1
    ds_read_b32 v162, v5 offset:24
    s_waitcnt lgkmcnt(0)
    v_readfirstlane_b32 s32, v162
    s_cmp_gt_u32 s32, 5
    s_cbranch_scc0 L_retry5
    ds_read_b32 v162, v5 offset:24
    ds_read_b128 v[136:139], v4 offset:39936
    ds_read_b128 v[140:143], v4 offset:40960
    ds_read_b128 v[144:147], v4 offset:41984
    ds_read_b128 v[148:151], v4 offset:43008
    ds_read_b128 v[152:155], v4 offset:44032
    ds_read_b128 v[156:159], v4 offset:45056
    s_branch L_chk5
L_retry6:
    s_sleep 1
    ds_read_b32 v160, v5 offset:28
    s_waitcnt lgkmcnt(0)
    v_readfirstlane_b32 s32, v160
    s_cmp_gt_u32 s32, 6
    s_cbranch_scc0 L_retry6
    ds_read_b32 v160, v5 offset:28
    ds_read_b128 v[112:115], v4 offset:49152
    ds_read_b128 v[116:119], v4 offset:50176
    ds_read_b128 v[120:123], v4 offset:51200
    ds_read_b128 v[124:127], v4 offset:52224
    ds_read_b128 v[128:131], v4 offset:53248
    ds_read_b128 v[132:135], v4 offset:54272
    s_branch L_chk6
L_retry7:
    s_sleep 1
    ds_read_b32 v162, v5 offset:28
    s_waitcnt lgkmcnt(0)
    v_readfirstlane_b32 s32, v162
    s_cmp_gt_u32 s32, 7
    s_cbranch_scc0 L_retry7
    ds_read_b32 v162, v5 offset:28
    ds_read_b128 v[136:139], v4 offset:55296
    ds_read_b128 v[140:143], v4 offset:56320
    ds_read_b128 v[144:147], v4 offset:57344
    ds_read_b128 v[148:151], v4 offset:58368
    ds_read_b128 v[152:155], v4 offset:59392
    ds_read_b128 v[156:159], v4 offset:60416
    s_branch L_chk7
L_retry8:
    s_sleep 1
    ds_read_b32 v160, v5 offset:16
    s_waitcnt lgkmcnt(0)
    v_readfirstlane_b32 s32, v160
    s_cmp_gt_u32 s32, 8
    s_cbranch_scc0 L_retry8
    ds_read_b32 v160, v5 offset:16
    ds_read_b128 v[112:115], v9 offset:3072
    ds_read_b128 v[116:119], v9 offset:4096
    ds_read_b128 v[120:123], v9 offset:5120
    ds_read_b128 v[124:127], v9 offset:6144
    ds_read_b128 v[128:131], v9 offset:7168
    ds_read_b128 v[132:135], v9 offset:8192
    s_branch L_chk8
L_retry9:
    s_sleep 1
    ds_read_b32 v162, v5 offset:16
    s_waitcnt lgkmcnt(0)
    v_readfirstlane_b32 s32, v162
    s_cmp_gt_u32 s32, 9
    s_cbranch_scc0 L_retry9
    ds_read_b32 v162, v5 offset:16
    ds_read_b128 v[136:139], v9 offset:9216
    ds_read_b128 v[140:143], v9 offset:10240
    ds_read_b128 v[144:147], v9 offset:11264
    ds_read_b128 v[148:151], v9 offset:12288
    ds_read_b128 v[152:155], v9 offset:13312
    ds_read_b128 v[156:159], v9 offset:14336
    s_branch L_chk9
L_retry10:
    s_sleep 1
    ds_read_b32 v160, v5 offset:20
    s_waitcnt lgkmcnt(0)
    v_readfirstlane_b32 s32, v160
    s_cmp_gt_u32 s32, 10
    s_cbranch_scc0 L_retry10
    ds_read_b32 v160, v5 offset:20
    ds_read_b128 v[112:115], v9 offset:18432
    ds_read_b128 v[116:119], v9 offset:19456
    ds_read_b128 v[120:123], v9 offset:20480
    ds_read_b128 v[124:127], v9 offset:21504
    ds_read_b128 v[128:131], v9 offset:22528
    ds_read_b128 v[132:135], v9 offset:23552
    s_branch L_chk10
L_retry11:
    s_sleep 1
    ds_read_b32 v162, v5 offset:20
    s_waitcnt lgkmcnt(0)
    v_readfirstlane_b32 s32, v162
    s_cmp_gt_u32 s32, 11
    s_cbranch_scc0 L_retry11
    ds_read_b32 v162, v5 offset:20
    ds_read_b128 v[136:139], v9 offset:24576
    ds_read_b128 v[140:143], v9 offset:25600
    ds_read_b128 v[144:147], v9 offset:26624
    ds_read_b128 v[148:151], v9 offset:27648
    ds_read_b128 v[152:155], v9 offset:28672
    ds_read_b128 v[156:159], v9 offset:29696
    s_branch L_chk11
L_retry12:
    s_sleep 1
    ds_read_b32 v160, v5 offset:24
    s_waitcnt lgkmcnt(0)
    v_readfirstlane_b32 s32, v160
    s_cmp_gt_u32 s32, 12
    s_cbranch_scc0 L_retry12
    ds_read_b32 v160, v5 offset:24
    ds_read_b128 v[112:115], v9 offset:33792
    ds_read_b128 v[116:119], v9 offset:34816
    ds_read_b128 v[120:123], v9 offset:35840
    ds_read_b128 v[124:127], v9 offset:36864
    ds_read_b128 v[128:131], v9 offset:37888
    ds_read_b128 v[132:135], v9 offset:38912
    s_branch L_chk12
L_retry13:
    s_sleep 1
    ds_read_b32 v162, v5 offset:24
    s_waitcnt lgkmcnt(0)
    v_readfirstlane_b32 s32, v162
    s_cmp_gt_u32 s32, 13
    s_cbranch_scc0 L_retry13
    ds_read_b32 v162, v5 offset:24
    ds_read_b128 v[136:139], v9 offset:39936
    ds_read_b128 v[140:143], v9 offset:40960
    ds_read_b128 v[144:147], v9 offset:41984
    ds_read_b128 v[148:151], v9 offset:43008
    ds_read_b128 v[152:155], v9 offset:44032
    ds_read_b128 v[156:159], v9 offset:45056
    s_branch L_chk13
L_retry14:
    s_sleep 1
    ds_read_b32 v160, v5 offset:28
    s_waitcnt lgkmcnt(0)
    v_readfirstlane_b32 s32, v160
    s_cmp_gt_u32 s32, 14
    s_cbranch_scc0 L_retry14
    ds_read_b32 v160, v5 offset:28
    ds_read_b128 v[112:115], v9 offset:49152
    ds_read_b128 v[116:119], v9 offset:50176
    ds_read_b128 v[120:123], v9 offset:51200
    ds_read_b128 v[124:127], v9 offset:52224
    ds_read_b128 v[128:131], v9 offset:53248
    ds_read_b128 v[132:135], v9 offset:54272
    s_branch L_chk14
L_retry15:
    s_sleep 1
    ds_read_b32 v162, v5 offset:28
    s_waitcnt lgkmcnt(0)
    v_readfirstlane_b32 s32, v162
    s_cmp_gt_u32 s32, 15
    s_cbranch_scc0 L_retry15
    ds_read_b32 v162, v5 offset:28
    ds_read_b128 v[136:139], v9 offset:55296
    ds_read_b128 v[140:143], v9 offset:56320
    ds_read_b128 v[144:147], v9 offset:57344
    ds_read_b128 v[148:151], v9 offset:58368
    ds_read_b128 v[152:155], v9 offset:59392
    ds_read_b128 v[156:159], v9 offset:60416
    s_branch L_chk15
L_retry16:
    s_sleep 1
    ds_read_b32 v160, v5 offset:16
    s_waitcnt lgkmcnt(0)
    v_readfirstlane_b32 s32, v160
    s_cmp_gt_u32 s32, 16
    s_cbranch_scc0 L_retry16
    ds_read_b32 v160, v5 offset:16
    ds_read_b128 v[112:115], v11 offset:3072
    ds_read_b128 v[116:119], v11 offset:4096
    ds_read_b128 v[120:123], v11 offset:5120
    ds_read_b128 v[124:127], v11 offset:6144
    ds_read_b128 v[128:131], v11 offset:7168
    ds_read_b128 v[132:135], v11 offset:8192
    s_branch L_chk16
L_retry17:
    s_sleep 1
    ds_read_b32 v162, v5 offset:16
    s_waitcnt lgkmcnt(0)
    v_readfirstlane_b32 s32, v162
    s_cmp_gt_u32 s32, 17
    s_cbranch_scc0 L_retry17
    ds_read_b32 v162, v5 offset:16
    ds_read_b128 v[136:139], v11 offset:9216
    ds_read_b128 v[140:143], v11 offset:10240
    ds_read_b128 v[144:147], v11 offset:11264
    ds_read_b128 v[148:151], v11 offset:12288
    ds_read_b128 v[152:155], v11 offset:13312
    ds_read_b128 v[156:159], v11 offset:14336
    s_branch L_chk17
L_retry18:
    s_sleep 1
    ds_read_b32 v160, v5 offset:20
    s_waitcnt lgkmcnt(0)
    v_readfirstlane_b32 s32, v160
    s_cmp_gt_u32 s32, 18
    s_cbranch_scc0 L_retry18
    ds_read_b32 v160, v5 offset:20
    ds_read_b128 v[112:115], v4 offset:3072
    ds_read_b128 v[116:119], v4 offset:4096
    ds_read_b128 v[120:123], v4 offset:5120
    ds_read_b128 v[124:127], v4 offset:6144
    ds_read_b128 v[128:131], v4 offset:7168
    ds_read_b128 v[132:135], v4 offset:8192
    s_branch L_chk18
L_retry19:
    s_sleep 1
    ds_read_b32 v162, v5 offset:20
    s_waitcnt lgkmcnt(0)
    v_readfirstlane_b32 s32, v162
    s_cmp_gt_u32 s32, 19
    s_cbranch_scc0 L_retry19
    ds_read_b32 v162, v5 offset:20
    ds_read_b128 v[136:139], v4 offset:9216
    ds_read_b128 v[140:143], v4 offset:10240
    ds_read_b128 v[144:147], v4 offset:11264
    ds_read_b128 v[148:151], v4 offset:12288
    ds_read_b128 v[152:155], v4 offset:13312
    ds_read_b128 v[156:159], v4 offset:14336
    s_branch L_chk19
L_retry20:
    s_sleep 1
    ds_read_b32 v160, v5 offset:24
    s_waitcnt lgkmcnt(0)
    v_readfirstlane_b32 s32, v160
    s_cmp_gt_u32 s32, 20
    s_cbranch_scc0 L_retry20
    ds_read_b32 v160, v5 offset:24
    ds_read_b128 v[112:115], v4 offset:18432
    ds_read_b128 v[116:119], v4 offset:19456
    ds_read_b128 v[120:123], v4 offset:20480
    ds_read_b128 v[124:127], v4 offset:21504
    ds_read_b128 v[128:131], v4 offset:22528
    ds_read_b128 v[132:135], v4 offset:23552
    s_branch L_chk20
L_retry21:
    s_sleep 1
    ds_read_b32 v162, v5 offset:24
    s_waitcnt lgkmcnt(0)
    v_readfirstlane_b32 s32, v162
    s_cmp_gt_u32 s32, 21
    s_cbranch_scc0 L_retry21
    ds_read_b32 v162, v5 offset:24
    ds_read_b128 v[136:139], v4 offset:24576
    ds_read_b128 v[140:143], v4 offset:25600
    ds_read_b128 v[144:147], v4 offset:26624
    ds_read_b128 v[148:151], v4 offset:27648
    ds_read_b128 v[152:155], v4 offset:28672
    ds_read_b128 v[156:159], v4 offset:29696
    s_branch L_chk21
L_fin:
L_end:
    s_endpgm
.section .rodata,"a"
.p2align 6
.amdhsa_kernel standalone__detection_seg_fpn_lateral__vision_kernel
  .amdhsa_next_free_vgpr 252
  .amdhsa_next_free_sgpr 64
  .amdhsa_accum_offset 252
  .amdhsa_group_segment_fixed_size 0
  .amdhsa_kernarg_size 56
  .amdhsa_user_sgpr_count 2
  .amdhsa_user_sgpr_kernarg_segment_ptr 1
  .amdhsa_system_sgpr_workgroup_id_x 1
  .amdhsa_float_denorm_mode_32 3
.end_amdhsa_kernel
```
